```python
import torch

def _softmax(x, axis=-1):
    return torch.softmax(x, dim=axis)
def _gelu(x):
    return torch.nn.functional.gelu(x, approximate="tanh")
def _silu(x):
    return torch.nn.functional.silu(x)
def _sigmoid(x):
    return torch.sigmoid(x)
def _layernorm(x, axis=-1, eps=1e-5):
    m = x.mean(dim=axis, keepdim=True)
    v = x.var(dim=axis, keepdim=True, unbiased=False)
    return (x - m) / torch.sqrt(v + eps)
def _scatter_add(tgt, idx, src, axis=0):
    return tgt.clone().index_add_(axis, idx, src)
def _segment_sum(src, seg, n):
    out = torch.zeros((n,) + src.shape[1:], dtype=src.dtype)
    return out.index_add_(0, seg, src)
def _pad(x, pw):
    flat = tuple(v for pair in reversed(pw) for v in pair)
    return torch.nn.functional.pad(x, flat)

kernel_name = 'gated_mix__gqa_block_cached__glu_gated_swiglu__decode'

def setup_inputs():

    _w = (lambda a: (lambda t: t.to(torch.bfloat16) if t.is_floating_point() else t)(torch.as_tensor(a)))
    def _A_setup():
        B, Sq, D = 2, 1, 448
        Hq, Hkv, Sk, Dh = 16, 8, 32768, 256
        assert Hq % Hkv == 0, (Hq, Hkv)
        return {
            "x": _w((lambda *s: torch.randn(*s, dtype=torch.bfloat16) * 0.05)(B, Sq, D)),
            "k_cache": _w((lambda *s: torch.randn(*s, dtype=torch.bfloat16) * 3.2)(B, Hkv, Sk, Dh)),
            "v_cache": _w((lambda *s: torch.randn(*s, dtype=torch.bfloat16) * 0.05)(B, Hkv, Sk, Dh)),
            "wq": _w((lambda *s: torch.randn(*s, dtype=torch.bfloat16) * 3.2)(D, Hq * Dh) * (D ** -0.5)),
            "wo": _w((lambda *s: torch.randn(*s, dtype=torch.bfloat16) * 0.05)(Hq * Dh, D) * ((Hq * Dh) ** -0.5)),
        }
    _A_in = _A_setup()

    def _B_setup():
        B, S, D, F = 2, 1, 448, 1792
        return {
            "x": _w((lambda *s: torch.randn(*s, dtype=torch.bfloat16) * 0.05)(B, S, D)),
            "w1": _w((lambda *s: torch.randn(*s, dtype=torch.bfloat16) * 0.1)(D, F) * (2.0 / D) ** 0.5),
            "w3": _w((lambda *s: torch.randn(*s, dtype=torch.bfloat16) * 0.1)(D, F) * (2.0 / D) ** 0.5),
            "w2": _w((lambda *s: torch.randn(*s, dtype=torch.bfloat16) * 0.1)(F, D) * (2.0 / F) ** 0.5),
        }
    _B_in = _B_setup()

    return {
        "A_x": _A_in["x"],
        "A_k_cache": _A_in["k_cache"],
        "A_v_cache": _A_in["v_cache"],
        "A_wq": _A_in["wq"],
        "A_wo": _A_in["wo"],
        "B_x": _B_in["x"],
        "B_w1": _B_in["w1"],
        "B_w3": _B_in["w3"],
        "B_w2": _B_in["w2"],
        "gate_w": _w((lambda *s: torch.randn(*s, dtype=torch.bfloat16) * 0.05)(448) * 16.0),
    }

def reference(A_x, A_k_cache, A_v_cache, A_wq, A_wo, B_x, B_w1, B_w3, B_w2, gate_w):
    def _A_ref(x, k_cache, v_cache, wq, wo):
        B, Sq, D = x.shape
        Hq, Dh = 16, 256
        Hkv = k_cache.shape[1]
        rep = Hq // Hkv
        q = (lambda x, *d: x.permute(*d))((x @ wq).reshape(B, Sq, Hq, Dh), 0, 2, 1, 3)
        k = (lambda x, n, axis: torch.repeat_interleave(x, n, dim=axis))(k_cache, rep, axis=1)
        v = (lambda x, n, axis: torch.repeat_interleave(x, n, dim=axis))(v_cache, rep, axis=1)
        scores = torch.einsum("bhqd,bhkd->bhqk", q, k) * (Dh ** -0.5)
        p = _softmax(scores, axis=-1)
        o = torch.einsum("bhqk,bhkd->bhqd", p, v)
        return (lambda x, *d: x.permute(*d))(o, 0, 2, 1, 3).reshape(B, Sq, Hq * Dh) @ wo

    def _B_ref(x, w1, w3, w2):
        gate = torch.einsum("bsd,df->bsf", x, w1)
        up = torch.einsum("bsd,df->bsf", x, w3)
        h = _silu(gate) * up
        out = torch.einsum("bsf,fd->bsd", h, w2)
        return out

    x = A_x
    g = _sigmoid((x * gate_w).sum(-1, keepdims=True))
    a = _A_ref(x, A_k_cache, A_v_cache, A_wq, A_wo)
    b = _B_ref(x, B_w1, B_w3, B_w2)
    return g * a + (1 - g) * b
```

```asm
; @launch grid=(256,1,1) block=(128,1,1) lds=86016
.amdgcn_target "amdgcn-amd-amdhsa--gfx950"
.text
.globl gated_mix__gqa_block_cached__glu_gated_swiglu__decode_kernel
.p2align 8
.type gated_mix__gqa_block_cached__glu_gated_swiglu__decode_kernel,@function
gated_mix__gqa_block_cached__glu_gated_swiglu__decode_kernel:
  s_cmp_ge_u32 s2, 256
  s_cbranch_scc1 L_exit
  s_load_dwordx16 s[16:31], s[0:1], 0
  v_readfirstlane_b32 s3, v0
  v_and_b32 v1, 63, v0
  v_and_b32 v2, 15, v0
  s_load_dwordx8 s[32:39], s[0:1], 64
  s_load_dwordx2 s[40:41], s[0:1], 96
  v_lshrrev_b32 v3, 4, v1
  v_mov_b32 v15, 0
  s_lshr_b32 s3, s3, 6
  s_cbranch_scc1 L_main_head
  s_getpc_b64 s[4:5]
L_pc:
  s_lshr_b32 s6, s2, 3
  s_mulk_i32 s6, 1152
  v_lshl_add_u32 v10, v0, 7, s6
  v_min_u32 v10, L_code_end-L_pc-4, v10
  v_add_co_u32 v10, vcc, s4, v10
  v_mov_b32 v11, s5
  s_mov_b64 exec, 511
  v_addc_co_u32 v11, vcc, 0, v11, vcc
  global_load_dword v255, v[10:11], off
  s_mov_b64 exec, -1
  s_and_b32 s4, s2, 7
  s_lshr_b32 s5, s2, 3
  v_lshrrev_b32 v10, 3, v2
  v_mul_u32_u24 v11, 28, v3
  v_mul_u32_u24 v12, 14, v10
  v_add_u32 v12, v11, v12
  v_lshlrev_b32 v12, 13, v12
  v_and_b32 v9, 7, v2
  v_lshl_add_u32 v12, v9, 4, v12
  v_mul_u32_u24 v10, 896, v10
  v_lshl_add_u32 v11, v11, 1, v10
  s_and_b32 s60, s5, 3
  s_mul_i32 s14, s60, 917504
  s_lshl_b32 s15, s4, 10
  s_add_u32 s14, s14, s15
  s_lshr_b32 s15, s5, 2
  s_lshl_b32 s15, s15, 7
  s_add_u32 s14, s14, s15
  s_mul_i32 s69, s60, 224
  v_mov_b32 v24, 0
  v_mov_b32 v25, 0
  v_mov_b32 v26, 0
  v_mov_b32 v27, 1
  ds_write_b128 v15, v[24:27] offset:1024
  ds_write_b96 v15, v[24:26] offset:1040
  s_mov_b32 s58, 3670016
  s_mov_b32 s59, 0x20000
  s_mov_b32 s78, 1792
  s_mov_b32 s79, 0x20000
  s_waitcnt lgkmcnt(0)
  s_mov_b32 s56, s22
  s_and_b32 s57, s23, 0xffff
  s_mov_b32 s76, s16
  s_and_b32 s77, s17, 0xffff
  buffer_load_dwordx4 v[168:171], v11, s[76:79], s69 offen offset:0
  buffer_load_dwordx4 v[172:175], v11, s[76:79], s69 offen offset:16
  buffer_load_dwordx4 v[176:179], v11, s[76:79], s69 offen offset:32
  buffer_load_dwordx2 v[180:181], v11, s[76:79], s69 offen offset:48
  buffer_load_dwordx4 v[112:115], v12, s[56:59], s14 offen nt
  s_addk_i32 s14, 8192
  buffer_load_dwordx4 v[116:119], v12, s[56:59], s14 offen nt
  s_addk_i32 s14, 8192
  buffer_load_dwordx4 v[120:123], v12, s[56:59], s14 offen nt
  s_addk_i32 s14, 8192
  buffer_load_dwordx4 v[124:127], v12, s[56:59], s14 offen nt
  s_addk_i32 s14, 8192
  buffer_load_dwordx4 v[128:131], v12, s[56:59], s14 offen nt
  s_addk_i32 s14, 8192
  buffer_load_dwordx4 v[132:135], v12, s[56:59], s14 offen nt
  s_addk_i32 s14, 8192
  buffer_load_dwordx4 v[136:139], v12, s[56:59], s14 offen nt
  s_addk_i32 s14, 8192
  buffer_load_dwordx4 v[140:143], v12, s[56:59], s14 offen nt
  s_addk_i32 s14, 8192
  buffer_load_dwordx4 v[144:147], v12, s[56:59], s14 offen nt
  s_addk_i32 s14, 8192
  buffer_load_dwordx4 v[148:151], v12, s[56:59], s14 offen nt
  s_addk_i32 s14, 8192
  buffer_load_dwordx4 v[152:155], v12, s[56:59], s14 offen nt
  s_addk_i32 s14, 8192
  buffer_load_dwordx4 v[156:159], v12, s[56:59], s14 offen nt
  s_addk_i32 s14, 8192
  buffer_load_dwordx4 v[160:163], v12, s[56:59], s14 offen nt
  s_addk_i32 s14, 8192
  buffer_load_dwordx4 v[164:167], v12, s[56:59], s14 offen nt
  s_load_dword s42, s[40:41], 0
  s_barrier
  s_branch L_helper_rest
L_main_head:
  v_lshrrev_b32 v4, 1, v2
  v_lshlrev_b32 v4, 10, v4
  v_and_b32 v9, 1, v2
  v_lshl_add_u32 v4, v9, 6, v4
  v_lshl_add_u32 v4, v3, 4, v4
  s_bfe_u32 s8, s2, 0x30000
  s_lshl_b32 s8, s8, 21
  s_bfe_u32 s15, s2, 0x10003
  s_lshl_b32 s15, s15, 16
  s_or_b32 s8, s8, s15
  s_bfe_u32 s15, s2, 0x40004
  s_lshl_b32 s15, s15, 24
  s_or_b32 s8, s8, s15
  s_mov_b32 s14, 1966080
  s_and_b32 s60, s8, 0xffffff
  s_sub_u32 s46, 0x1000000, s60
  s_mov_b32 s47, 0x20000
  s_waitcnt lgkmcnt(0)
  s_add_u32 s44, s18, s8
  s_addc_u32 s45, s19, 0
  s_and_b32 s45, s45, 0xffff
  s_barrier
  buffer_load_dwordx4 a[0:3], v4, s[44:47], s14 offen offset:0 nt
  buffer_load_dwordx4 a[4:7], v4, s[44:47], s14 offen offset:128 nt
  buffer_load_dwordx4 a[8:11], v4, s[44:47], s14 offen offset:256 nt
  buffer_load_dwordx4 a[12:15], v4, s[44:47], s14 offen offset:384 nt
  buffer_load_dwordx4 a[16:19], v4, s[44:47], s14 offen offset:512 nt
  buffer_load_dwordx4 a[20:23], v4, s[44:47], s14 offen offset:640 nt
  buffer_load_dwordx4 a[24:27], v4, s[44:47], s14 offen offset:768 nt
  buffer_load_dwordx4 a[28:31], v4, s[44:47], s14 offen offset:896 nt
  s_or_b32 s14, s14, 0xe10000
  s_add_u32 s14, s14, 8192
  s_and_b32 s14, s14, 0xff1ee000
  buffer_load_dwordx4 a[32:35], v4, s[44:47], s14 offen offset:0 nt
  buffer_load_dwordx4 a[36:39], v4, s[44:47], s14 offen offset:128 nt
  buffer_load_dwordx4 a[40:43], v4, s[44:47], s14 offen offset:256 nt
  buffer_load_dwordx4 a[44:47], v4, s[44:47], s14 offen offset:384 nt
  buffer_load_dwordx4 a[48:51], v4, s[44:47], s14 offen offset:512 nt
  buffer_load_dwordx4 a[52:55], v4, s[44:47], s14 offen offset:640 nt
  buffer_load_dwordx4 a[56:59], v4, s[44:47], s14 offen offset:768 nt
  buffer_load_dwordx4 a[60:63], v4, s[44:47], s14 offen offset:896 nt
  s_or_b32 s14, s14, 0xe10000
  s_add_u32 s14, s14, 8192
  s_and_b32 s14, s14, 0xff1ee000
  buffer_load_dwordx4 a[64:67], v4, s[44:47], s14 offen offset:0 nt
  buffer_load_dwordx4 a[68:71], v4, s[44:47], s14 offen offset:128 nt
  buffer_load_dwordx4 a[72:75], v4, s[44:47], s14 offen offset:256 nt
  buffer_load_dwordx4 a[76:79], v4, s[44:47], s14 offen offset:384 nt
  buffer_load_dwordx4 a[80:83], v4, s[44:47], s14 offen offset:512 nt
L_main:
  v_lshlrev_b32 v105, 4, v1
  s_mov_b32 s10, 0x3db8aa3b
  s_mov_b32 s64, 0
  s_mov_b32 s65, -1
  s_lshr_b32 s6, s8, 24
  s_mov_b32 s7, 0
  s_bfe_u32 s15, s2, 0x10000
  s_lshl_b32 s15, s15, 0
  s_or_b32 s7, s7, s15
  s_bfe_u32 s15, s2, 0x10001
  s_lshl_b32 s15, s15, 1
  s_or_b32 s7, s7, s15
  s_bfe_u32 s15, s2, 0x10002
  s_lshl_b32 s15, s15, 2
  s_or_b32 s7, s7, s15
  s_bfe_u32 s15, s2, 0x10003
  s_lshl_b32 s15, s15, 3
  s_or_b32 s7, s7, s15
  s_mov_b32 s50, s46
  s_mov_b32 s51, 0x20000
  s_add_u32 s48, s20, s8
  s_addc_u32 s49, s21, 0
  s_and_b32 s49, s49, 0xffff
  s_mov_b32 s52, s40
  s_and_b32 s53, s41, 0xffff
  s_mov_b32 s54, 8388608
  s_mov_b32 s55, 0x20000
  s_load_dword s42, s[40:41], 0
  v_lshlrev_b32 v5, 11, v3
  v_lshl_add_u32 v5, v2, 4, v5
  v_and_b32 v9, 1, v2
  v_lshlrev_b32 v9, 4, v9
  v_mov_b32 v10, 0xffff
  v_lshlrev_b32 v9, v9, v10
  v_bfe_u32 v10, v2, 1, 2
  v_cmp_eq_u32 vcc, 0, v10
  s_nop 1
  v_cndmask_b32 v16, 0, v9, vcc
  v_cmp_eq_u32 vcc, 1, v10
  s_nop 1
  v_cndmask_b32 v17, 0, v9, vcc
  v_cmp_eq_u32 vcc, 2, v10
  s_nop 1
  v_cndmask_b32 v18, 0, v9, vcc
  v_cmp_eq_u32 vcc, 3, v10
  s_nop 1
  v_cndmask_b32 v19, 0, v9, vcc
  v_mov_b32 v6, 0xff61b1e6
  v_mov_b32 v40, 0
  v_mov_b32 v28, 0xfe967699
  v_mov_b32 v41, 0
  v_mov_b32 v29, 0xfe967699
  v_mov_b32 v42, 0
  v_mov_b32 v30, 0xfe967699
  v_mov_b32 v43, 0
  v_mov_b32 v31, 0xfe967699
  v_mov_b32 v44, 0
  v_mov_b32 v32, 0xfe967699
  v_mov_b32 v45, 0
  v_mov_b32 v33, 0xfe967699
  v_mov_b32 v46, 0
  v_mov_b32 v34, 0xfe967699
  v_mov_b32 v47, 0
  v_mov_b32 v35, 0xfe967699
  v_lshrrev_b32 v107, 3, v2
  v_lshlrev_b32 v107, 6, v107
  v_lshl_add_u32 v107, v3, 4, v107
  s_mov_b32 s75, 0
  v_lshrrev_b32 v241, 1, v3
  v_lshlrev_b32 v240, 4, v241
  v_lshlrev_b32 v241, 2, v241
  v_and_b32 v9, 1, v3
  v_lshl_add_u32 v240, v9, 2, v240
  v_lshrrev_b32 v9, 2, v2
  v_add_u32 v240, v240, v9
  v_lshlrev_b32 v240, 11, v240
  v_and_b32 v9, 3, v2
  v_lshl_add_u32 v240, v9, 4, v240
  s_and_b32 s15, s6, 7
  s_lshl_b32 s70, s15, 16
  s_lshr_b32 s15, s6, 3
  s_lshl_b32 s15, s15, 4
  s_add_u32 s15, s15, s7
  s_lshl_b32 s60, s15, 6
  s_add_u32 s70, s70, s60
  s_add_u32 s70, s70, 2097152
  s_add_u32 s71, s70, 16384
  s_waitcnt lgkmcnt(0)
  s_add_u32 s9, s42, 1
  s_and_b32 s43, s9, 0xff
  s_lshr_b32 s15, s9, 8
  s_add_u32 s15, s15, s9
  s_and_b32 s15, s15, 0xff
  s_lshl_b32 s15, s15, 8
  s_or_b32 s43, s43, s15
  s_lshr_b32 s15, s9, 16
  s_add_u32 s15, s15, s9
  s_and_b32 s15, s15, 0xff
  s_lshl_b32 s15, s15, 16
  s_or_b32 s43, s43, s15
  s_lshr_b32 s15, s9, 24
  s_add_u32 s15, s15, s9
  s_and_b32 s15, s15, 0xff
  s_lshl_b32 s15, s15, 24
  s_or_b32 s43, s43, s15
  v_mov_b32 v106, s43
  s_mov_b32 s96, 0x7060500
  s_mov_b32 s97, 0x7060501
  s_mov_b32 s98, 0x7060502
  s_mov_b32 s99, 0x7060503
  s_mov_b32 s62, 0x01010101
  s_mov_b32 s63, 0x01010101
  s_waitcnt vmcnt(20)
  buffer_load_dwordx4 a[84:87], v4, s[44:47], s14 offen offset:640 nt
  s_waitcnt vmcnt(20)
  buffer_load_dwordx4 a[88:91], v4, s[44:47], s14 offen offset:768 nt
  s_waitcnt vmcnt(20)
  buffer_load_dwordx4 a[92:95], v4, s[44:47], s14 offen offset:896 nt
  s_or_b32 s14, s14, 0xe10000
  s_add_u32 s14, s14, 8192
  s_and_b32 s14, s14, 0xff1ee000
  s_waitcnt vmcnt(20)
  buffer_load_dwordx4 a[96:99], v4, s[44:47], s14 offen offset:0 nt
  s_waitcnt vmcnt(20)
  buffer_load_dwordx4 a[100:103], v4, s[44:47], s14 offen offset:128 nt
  s_waitcnt vmcnt(20)
  buffer_load_dwordx4 a[104:107], v4, s[44:47], s14 offen offset:256 nt
  s_waitcnt vmcnt(20)
  buffer_load_dwordx4 a[108:111], v4, s[44:47], s14 offen offset:384 nt
  s_waitcnt vmcnt(20)
  buffer_load_dwordx4 a[112:115], v4, s[44:47], s14 offen offset:512 nt
  s_waitcnt vmcnt(20)
  buffer_load_dwordx4 a[116:119], v4, s[44:47], s14 offen offset:640 nt
  s_waitcnt vmcnt(20)
  buffer_load_dwordx4 a[120:123], v4, s[44:47], s14 offen offset:768 nt
  s_waitcnt vmcnt(20)
  buffer_load_dwordx4 a[124:127], v4, s[44:47], s14 offen offset:896 nt
  s_or_b32 s14, s14, 0xe10000
  s_add_u32 s14, s14, 8192
  s_and_b32 s14, s14, 0xff1ee000
  s_waitcnt vmcnt(20)
  buffer_load_dwordx4 a[128:131], v4, s[44:47], s14 offen offset:0 nt
  s_waitcnt vmcnt(20)
  buffer_load_dwordx4 a[132:135], v4, s[44:47], s14 offen offset:128 nt
  s_waitcnt vmcnt(20)
  buffer_load_dwordx4 a[136:139], v4, s[44:47], s14 offen offset:256 nt
  s_waitcnt vmcnt(20)
  buffer_load_dwordx4 a[140:143], v4, s[44:47], s14 offen offset:384 nt
  s_waitcnt vmcnt(20)
  buffer_load_dwordx4 a[144:147], v4, s[44:47], s14 offen offset:512 nt
  s_waitcnt vmcnt(20)
  buffer_load_dwordx4 a[148:151], v4, s[44:47], s14 offen offset:640 nt
  s_waitcnt vmcnt(20)
  buffer_load_dwordx4 a[152:155], v4, s[44:47], s14 offen offset:768 nt
  s_waitcnt vmcnt(20)
  buffer_load_dwordx4 a[156:159], v4, s[44:47], s14 offen offset:896 nt
  s_or_b32 s14, s14, 0xe10000
  s_add_u32 s14, s14, 8192
  s_and_b32 s14, s14, 0xff1ee000
  s_waitcnt vmcnt(20)
  buffer_load_dwordx4 a[160:163], v4, s[44:47], s14 offen offset:0 nt
  s_waitcnt vmcnt(20)
  buffer_load_dwordx4 a[164:167], v4, s[44:47], s14 offen offset:128 nt
  s_waitcnt vmcnt(20)
  buffer_load_dwordx4 a[168:171], v4, s[44:47], s14 offen offset:256 nt
  s_waitcnt vmcnt(20)
  buffer_load_dwordx4 a[172:175], v4, s[44:47], s14 offen offset:384 nt
  s_waitcnt vmcnt(20)
  buffer_load_dwordx4 a[176:179], v4, s[44:47], s14 offen offset:512 nt
  s_waitcnt vmcnt(20)
  buffer_load_dwordx4 a[180:183], v4, s[44:47], s14 offen offset:640 nt
  s_waitcnt vmcnt(20)
  buffer_load_dwordx4 a[184:187], v4, s[44:47], s14 offen offset:768 nt
  s_waitcnt vmcnt(20)
  buffer_load_dwordx4 a[188:191], v4, s[44:47], s14 offen offset:896 nt
  s_or_b32 s14, s14, 0xe10000
  s_add_u32 s14, s14, 8192
  s_and_b32 s14, s14, 0xff1ee000
  v_mov_b32 v9, 1
  ds_write_b32 v15, v9 offset:1024
  s_waitcnt vmcnt(20)
  buffer_load_dwordx4 a[192:195], v4, s[44:47], s14 offen offset:0 nt
  s_waitcnt vmcnt(20)
  buffer_load_dwordx4 a[196:199], v4, s[44:47], s14 offen offset:128 nt
  s_waitcnt vmcnt(20)
  buffer_load_dwordx4 a[200:203], v4, s[44:47], s14 offen offset:256 nt
  s_waitcnt vmcnt(20)
  buffer_load_dwordx4 a[204:207], v4, s[44:47], s14 offen offset:384 nt
  s_waitcnt vmcnt(20)
  buffer_load_dwordx4 a[208:211], v4, s[44:47], s14 offen offset:512 nt
  s_waitcnt vmcnt(20)
  buffer_load_dwordx4 a[212:215], v4, s[44:47], s14 offen offset:640 nt
  s_waitcnt vmcnt(20)
  buffer_load_dwordx4 a[216:219], v4, s[44:47], s14 offen offset:768 nt
  s_waitcnt vmcnt(20)
  buffer_load_dwordx4 a[220:223], v4, s[44:47], s14 offen offset:896 nt
  s_or_b32 s14, s14, 0xe10000
  s_add_u32 s14, s14, 8192
  s_and_b32 s14, s14, 0xff1ee000
  s_waitcnt vmcnt(20)
  buffer_load_dwordx4 a[224:227], v4, s[44:47], s14 offen offset:0 nt
  s_waitcnt vmcnt(20)
  buffer_load_dwordx4 a[228:231], v4, s[44:47], s14 offen offset:128 nt
  s_waitcnt vmcnt(20)
  buffer_load_dwordx4 a[232:235], v4, s[44:47], s14 offen offset:256 nt
  s_waitcnt vmcnt(20)
  buffer_load_dwordx4 a[236:239], v4, s[44:47], s14 offen offset:384 nt
  s_waitcnt vmcnt(20)
  buffer_load_dwordx4 a[240:243], v4, s[44:47], s14 offen offset:512 nt
  s_waitcnt vmcnt(20)
  buffer_load_dwordx4 a[244:247], v4, s[44:47], s14 offen offset:640 nt
  s_waitcnt vmcnt(20)
  buffer_load_dwordx4 a[248:251], v4, s[44:47], s14 offen offset:768 nt
  s_waitcnt vmcnt(20)
  buffer_load_dwordx4 a[252:255], v4, s[44:47], s14 offen offset:896 nt
  s_mov_b32 s14, 0
  s_waitcnt vmcnt(20)
  buffer_load_dwordx4 v[112:115], v4, s[44:47], s14 offen offset:0 nt
  s_waitcnt vmcnt(20)
  buffer_load_dwordx4 v[116:119], v4, s[44:47], s14 offen offset:128 nt
  s_waitcnt vmcnt(20)
  buffer_load_dwordx4 v[120:123], v4, s[44:47], s14 offen offset:256 nt
  s_waitcnt vmcnt(20)
  buffer_load_dwordx4 v[124:127], v4, s[44:47], s14 offen offset:384 nt
  s_waitcnt vmcnt(20)
  buffer_load_dwordx4 v[128:131], v4, s[44:47], s14 offen offset:512 nt
  s_waitcnt vmcnt(20)
  buffer_load_dwordx4 v[132:135], v4, s[44:47], s14 offen offset:640 nt
  s_waitcnt vmcnt(20)
  buffer_load_dwordx4 v[136:139], v4, s[44:47], s14 offen offset:768 nt
  s_waitcnt vmcnt(20)
  buffer_load_dwordx4 v[140:143], v4, s[44:47], s14 offen offset:896 nt
  s_or_b32 s14, s14, 0xe10000
  s_add_u32 s14, s14, 8192
  s_and_b32 s14, s14, 0xff1ee000
  s_waitcnt vmcnt(20)
  buffer_load_dwordx4 v[144:147], v4, s[44:47], s14 offen offset:0 nt
  s_waitcnt vmcnt(20)
  buffer_load_dwordx4 v[148:151], v4, s[44:47], s14 offen offset:128 nt
  s_waitcnt vmcnt(20)
  buffer_load_dwordx4 v[152:155], v4, s[44:47], s14 offen offset:256 nt
  s_waitcnt vmcnt(20)
  buffer_load_dwordx4 v[156:159], v4, s[44:47], s14 offen offset:384 nt
  s_waitcnt vmcnt(20)
  buffer_load_dwordx4 v[160:163], v4, s[44:47], s14 offen offset:512 nt
  s_waitcnt vmcnt(20)
  buffer_load_dwordx4 v[164:167], v4, s[44:47], s14 offen offset:640 nt
  s_waitcnt vmcnt(20)
  buffer_load_dwordx4 v[168:171], v4, s[44:47], s14 offen offset:768 nt
  s_waitcnt vmcnt(20)
  buffer_load_dwordx4 v[172:175], v4, s[44:47], s14 offen offset:896 nt
  s_or_b32 s14, s14, 0xe10000
  s_add_u32 s14, s14, 8192
  s_and_b32 s14, s14, 0xff1ee000
  s_waitcnt vmcnt(20)
  buffer_load_dwordx4 v[176:179], v4, s[44:47], s14 offen offset:0 nt
  s_waitcnt vmcnt(20)
  buffer_load_dwordx4 v[180:183], v4, s[44:47], s14 offen offset:128 nt
  s_waitcnt vmcnt(20)
  buffer_load_dwordx4 v[184:187], v4, s[44:47], s14 offen offset:256 nt
  s_waitcnt vmcnt(20)
  buffer_load_dwordx4 v[188:191], v4, s[44:47], s14 offen offset:384 nt
  s_waitcnt vmcnt(20)
  buffer_load_dwordx4 v[192:195], v4, s[44:47], s14 offen offset:512 nt
  s_waitcnt vmcnt(20)
  buffer_load_dwordx4 v[196:199], v4, s[44:47], s14 offen offset:640 nt
  s_waitcnt vmcnt(20)
  buffer_load_dwordx4 v[200:203], v4, s[44:47], s14 offen offset:768 nt
  s_waitcnt vmcnt(20)
  buffer_load_dwordx4 v[204:207], v4, s[44:47], s14 offen offset:896 nt
  s_or_b32 s14, s14, 0xe10000
  s_add_u32 s14, s14, 8192
  s_and_b32 s14, s14, 0xff1ee000
  s_waitcnt vmcnt(20)
  buffer_load_dwordx4 v[208:211], v4, s[44:47], s14 offen offset:0 nt
  s_waitcnt vmcnt(20)
  buffer_load_dwordx4 v[212:215], v4, s[44:47], s14 offen offset:128 nt
  s_waitcnt vmcnt(20)
  buffer_load_dwordx4 v[216:219], v4, s[44:47], s14 offen offset:256 nt
  s_waitcnt vmcnt(20)
  buffer_load_dwordx4 v[220:223], v4, s[44:47], s14 offen offset:384 nt
  s_waitcnt vmcnt(20)
  buffer_load_dwordx4 v[224:227], v4, s[44:47], s14 offen offset:512 nt
  s_waitcnt vmcnt(20)
  buffer_load_dwordx4 v[228:231], v4, s[44:47], s14 offen offset:640 nt
  s_waitcnt vmcnt(20)
  buffer_load_dwordx4 v[232:235], v4, s[44:47], s14 offen offset:768 nt
  s_waitcnt vmcnt(20)
  buffer_load_dwordx4 v[236:239], v4, s[44:47], s14 offen offset:896 nt
  s_or_b32 s14, s14, 0xe10000
  s_add_u32 s14, s14, 8192
  s_and_b32 s14, s14, 0xff1ee000
  s_barrier
  v_lshrrev_b32 v9, 3, v2
  v_lshlrev_b32 v9, 9, v9
  v_lshl_add_u32 v9, v3, 4, v9
  v_and_b32 v10, 1, v2
  v_lshl_add_u32 v9, v10, 6, v9
  ds_read_b128 v[80:83], v9 offset:0
  ds_read_b128 v[84:87], v9 offset:128
  ds_read_b128 v[88:91], v9 offset:256
  ds_read_b128 v[92:95], v9 offset:384
  s_waitcnt lgkmcnt(0)
  v_mfma_f32_16x16x32_bf16 v[20:23], v[112:115], v[80:83], 0
  v_mfma_f32_16x16x32_bf16 v[48:51], a[0:3], v[80:83], 0
  v_mfma_f32_16x16x32_bf16 v[20:23], v[116:119], v[84:87], v[20:23]
  v_mfma_f32_16x16x32_bf16 v[48:51], a[4:7], v[84:87], v[48:51]
  v_mfma_f32_16x16x32_bf16 v[20:23], v[120:123], v[88:91], v[20:23]
  v_add_f32_dpp v36, v29, v28 quad_perm:[1,1,3,3] row_mask:0xf bank_mask:0xf
  v_add_f32_dpp v38, v31, v30 quad_perm:[1,1,3,3] row_mask:0xf bank_mask:0xf
  v_mfma_f32_16x16x32_bf16 v[48:51], a[8:11], v[88:91], v[48:51]
  v_mfma_f32_16x16x32_bf16 v[20:23], v[124:127], v[92:95], v[20:23]
  v_add_f32_dpp v37, v33, v32 quad_perm:[1,1,3,3] row_mask:0xf bank_mask:0xf
  v_add_f32_dpp v39, v35, v34 quad_perm:[1,1,3,3] row_mask:0xf bank_mask:0xf
  v_cvt_pk_bf16_f32 v37, v36, v37
  v_cvt_pk_bf16_f32 v39, v38, v39
  v_mfma_f32_16x16x32_bf16 v[48:51], a[12:15], v[92:95], v[48:51]
  v_mfma_f32_16x16x32_bf16 v[24:27], v[128:131], v[80:83], 0
  v_lshlrev_b32 v36, 16, v37
  v_lshlrev_b32 v38, 16, v39
  v_and_b32 v37, 0xffff0000, v37
  v_and_b32 v39, 0xffff0000, v39
  v_mfma_f32_16x16x32_bf16 v[52:55], a[16:19], v[80:83], 0
  v_mfma_f32_16x16x32_bf16 v[24:27], v[132:135], v[84:87], v[24:27]
  s_mov_b64 exec, s[62:63]
  ds_write_b128 v107, v[36:39] offset:4480
  s_mov_b64 exec, -1
  v_max3_f32 v6, v6, v36, v38
  v_max3_f32 v6, v6, v37, v39
  v_mfma_f32_16x16x32_bf16 v[52:55], a[20:23], v[84:87], v[52:55]
  v_mfma_f32_16x16x32_bf16 v[24:27], v[136:139], v[88:91], v[24:27]
  v_mfma_f32_16x16x32_bf16 v[52:55], a[24:27], v[88:91], v[52:55]
  v_mfma_f32_16x16x32_bf16 v[24:27], v[140:143], v[92:95], v[24:27]
  v_mfma_f32_16x16x32_bf16 v[52:55], a[28:31], v[92:95], v[52:55]
  s_waitcnt vmcnt(20)
  v_mfma_f32_16x16x32_bf16 v[28:31], v[144:147], v[80:83], 0
  buffer_load_dwordx4 v[112:115], v4, s[44:47], s14 offen offset:0 nt
  v_mfma_f32_16x16x32_bf16 v[56:59], a[32:35], v[80:83], 0
  s_waitcnt vmcnt(20)
  v_mfma_f32_16x16x32_bf16 v[28:31], v[148:151], v[84:87], v[28:31]
  buffer_load_dwordx4 v[116:119], v4, s[44:47], s14 offen offset:128 nt
  v_mfma_f32_16x16x32_bf16 v[56:59], a[36:39], v[84:87], v[56:59]
  s_waitcnt vmcnt(20)
  v_mfma_f32_16x16x32_bf16 v[28:31], v[152:155], v[88:91], v[28:31]
  buffer_load_dwordx4 v[120:123], v4, s[44:47], s14 offen offset:256 nt
  v_add_f32_dpp v36, v21, v20 quad_perm:[1,1,3,3] row_mask:0xf bank_mask:0xf
  v_add_f32_dpp v38, v23, v22 quad_perm:[1,1,3,3] row_mask:0xf bank_mask:0xf
  v_mfma_f32_16x16x32_bf16 v[56:59], a[40:43], v[88:91], v[56:59]
  v_add_f32_dpp v64, v49, v48 quad_perm:[1,1,3,3] row_mask:0xf bank_mask:0xf
  v_add_f32_dpp v66, v51, v50 quad_perm:[1,1,3,3] row_mask:0xf bank_mask:0xf
  s_waitcnt vmcnt(20)
  v_mfma_f32_16x16x32_bf16 v[28:31], v[156:159], v[92:95], v[28:31]
  buffer_load_dwordx4 v[124:127], v4, s[44:47], s14 offen offset:384 nt
  v_add_f32_dpp v37, v25, v24 quad_perm:[1,1,3,3] row_mask:0xf bank_mask:0xf
  v_add_f32_dpp v39, v27, v26 quad_perm:[1,1,3,3] row_mask:0xf bank_mask:0xf
  v_cvt_pk_bf16_f32 v37, v36, v37
  v_cvt_pk_bf16_f32 v39, v38, v39
  v_mfma_f32_16x16x32_bf16 v[56:59], a[44:47], v[92:95], v[56:59]
  v_add_f32_dpp v65, v53, v52 quad_perm:[1,1,3,3] row_mask:0xf bank_mask:0xf
  v_add_f32_dpp v67, v55, v54 quad_perm:[1,1,3,3] row_mask:0xf bank_mask:0xf
  v_cvt_pk_bf16_f32 v65, v64, v65
  v_cvt_pk_bf16_f32 v67, v66, v67
  s_waitcnt vmcnt(20)
  v_mfma_f32_16x16x32_bf16 v[32:35], v[160:163], v[80:83], 0
  buffer_load_dwordx4 v[128:131], v4, s[44:47], s14 offen offset:512 nt
  v_lshlrev_b32 v36, 16, v37
  v_lshlrev_b32 v38, 16, v39
  v_and_b32 v37, 0xffff0000, v37
  v_and_b32 v39, 0xffff0000, v39
  v_mfma_f32_16x16x32_bf16 v[60:63], a[48:51], v[80:83], 0
  v_lshlrev_b32 v64, 16, v65
  v_lshlrev_b32 v66, 16, v67
  v_and_b32 v65, 0xffff0000, v65
  v_and_b32 v67, 0xffff0000, v67
  s_waitcnt vmcnt(20)
  v_mfma_f32_16x16x32_bf16 v[32:35], v[164:167], v[84:87], v[32:35]
  buffer_load_dwordx4 v[132:135], v4, s[44:47], s14 offen offset:640 nt
  s_mov_b64 exec, s[62:63]
  ds_write_b128 v107, v[36:39] offset:4608
  s_mov_b64 exec, -1
  v_max3_f32 v6, v6, v36, v38
  v_max3_f32 v6, v6, v37, v39
  v_mfma_f32_16x16x32_bf16 v[60:63], a[52:55], v[84:87], v[60:63]
  s_mov_b64 exec, s[62:63]
  ds_write_b128 v107, v[64:67] offset:19968
  s_mov_b64 exec, -1
  v_max3_f32 v6, v6, v64, v66
  v_max3_f32 v6, v6, v65, v67
  s_waitcnt vmcnt(20)
  v_mfma_f32_16x16x32_bf16 v[32:35], v[168:171], v[88:91], v[32:35]
  buffer_load_dwordx4 v[136:139], v4, s[44:47], s14 offen offset:768 nt
  v_mfma_f32_16x16x32_bf16 v[60:63], a[56:59], v[88:91], v[60:63]
  s_waitcnt vmcnt(20)
  v_mfma_f32_16x16x32_bf16 v[32:35], v[172:175], v[92:95], v[32:35]
  buffer_load_dwordx4 v[140:143], v4, s[44:47], s14 offen offset:896 nt
  v_mfma_f32_16x16x32_bf16 v[60:63], a[60:63], v[92:95], v[60:63]
  s_or_b32 s14, s14, 0xe10000
  s_add_u32 s14, s14, 8192
  s_and_b32 s14, s14, 0xff1ee000
  s_waitcnt vmcnt(20)
  v_mfma_f32_16x16x32_bf16 v[20:23], v[176:179], v[80:83], 0
  buffer_load_dwordx4 v[144:147], v4, s[44:47], s14 offen offset:0 nt
  v_mfma_f32_16x16x32_bf16 v[48:51], a[64:67], v[80:83], 0
  s_waitcnt vmcnt(20)
  v_mfma_f32_16x16x32_bf16 v[20:23], v[180:183], v[84:87], v[20:23]
  buffer_load_dwordx4 v[148:151], v4, s[44:47], s14 offen offset:128 nt
  v_mfma_f32_16x16x32_bf16 v[48:51], a[68:71], v[84:87], v[48:51]
  s_waitcnt vmcnt(20)
  v_mfma_f32_16x16x32_bf16 v[20:23], v[184:187], v[88:91], v[20:23]
  buffer_load_dwordx4 v[152:155], v4, s[44:47], s14 offen offset:256 nt
  v_add_f32_dpp v36, v29, v28 quad_perm:[1,1,3,3] row_mask:0xf bank_mask:0xf
  v_add_f32_dpp v38, v31, v30 quad_perm:[1,1,3,3] row_mask:0xf bank_mask:0xf
  v_mfma_f32_16x16x32_bf16 v[48:51], a[72:75], v[88:91], v[48:51]
  v_add_f32_dpp v64, v57, v56 quad_perm:[1,1,3,3] row_mask:0xf bank_mask:0xf
  v_add_f32_dpp v66, v59, v58 quad_perm:[1,1,3,3] row_mask:0xf bank_mask:0xf
  s_waitcnt vmcnt(20)
  v_mfma_f32_16x16x32_bf16 v[20:23], v[188:191], v[92:95], v[20:23]
  buffer_load_dwordx4 v[156:159], v4, s[44:47], s14 offen offset:384 nt
  v_add_f32_dpp v37, v33, v32 quad_perm:[1,1,3,3] row_mask:0xf bank_mask:0xf
  v_add_f32_dpp v39, v35, v34 quad_perm:[1,1,3,3] row_mask:0xf bank_mask:0xf
  v_cvt_pk_bf16_f32 v37, v36, v37
  v_cvt_pk_bf16_f32 v39, v38, v39
  v_mfma_f32_16x16x32_bf16 v[48:51], a[76:79], v[92:95], v[48:51]
  v_add_f32_dpp v65, v61, v60 quad_perm:[1,1,3,3] row_mask:0xf bank_mask:0xf
  v_add_f32_dpp v67, v63, v62 quad_perm:[1,1,3,3] row_mask:0xf bank_mask:0xf
  v_cvt_pk_bf16_f32 v65, v64, v65
  v_cvt_pk_bf16_f32 v67, v66, v67
  s_waitcnt vmcnt(20)
  v_mfma_f32_16x16x32_bf16 v[24:27], v[192:195], v[80:83], 0
  buffer_load_dwordx4 v[160:163], v4, s[44:47], s14 offen offset:512 nt
  v_lshlrev_b32 v36, 16, v37
  v_lshlrev_b32 v38, 16, v39
  v_and_b32 v37, 0xffff0000, v37
  v_and_b32 v39, 0xffff0000, v39
  v_mfma_f32_16x16x32_bf16 v[52:55], a[80:83], v[80:83], 0
  v_lshlrev_b32 v64, 16, v65
  v_lshlrev_b32 v66, 16, v67
  v_and_b32 v65, 0xffff0000, v65
  v_and_b32 v67, 0xffff0000, v67
  s_waitcnt vmcnt(20)
  v_mfma_f32_16x16x32_bf16 v[24:27], v[196:199], v[84:87], v[24:27]
  buffer_load_dwordx4 v[164:167], v4, s[44:47], s14 offen offset:640 nt
  s_mov_b64 exec, s[62:63]
  ds_write_b128 v107, v[36:39] offset:4736
  s_mov_b64 exec, -1
  v_max3_f32 v6, v6, v36, v38
  v_max3_f32 v6, v6, v37, v39
  v_mfma_f32_16x16x32_bf16 v[52:55], a[84:87], v[84:87], v[52:55]
  s_mov_b64 exec, s[62:63]
  ds_write_b128 v107, v[64:67] offset:20096
  s_mov_b64 exec, -1
  v_max3_f32 v6, v6, v64, v66
  v_max3_f32 v6, v6, v65, v67
  s_waitcnt vmcnt(20)
  v_mfma_f32_16x16x32_bf16 v[24:27], v[200:203], v[88:91], v[24:27]
  buffer_load_dwordx4 v[168:171], v4, s[44:47], s14 offen offset:768 nt
  v_mfma_f32_16x16x32_bf16 v[52:55], a[88:91], v[88:91], v[52:55]
  s_waitcnt vmcnt(20)
  v_mfma_f32_16x16x32_bf16 v[24:27], v[204:207], v[92:95], v[24:27]
  buffer_load_dwordx4 v[172:175], v4, s[44:47], s14 offen offset:896 nt
  v_mfma_f32_16x16x32_bf16 v[52:55], a[92:95], v[92:95], v[52:55]
  s_or_b32 s14, s14, 0xe10000
  s_add_u32 s14, s14, 8192
  s_and_b32 s14, s14, 0xff1ee000
  s_waitcnt vmcnt(20)
  v_mfma_f32_16x16x32_bf16 v[28:31], v[208:211], v[80:83], 0
  buffer_load_dwordx4 v[176:179], v4, s[44:47], s14 offen offset:0 nt
  v_mfma_f32_16x16x32_bf16 v[56:59], a[96:99], v[80:83], 0
  s_waitcnt vmcnt(20)
  v_mfma_f32_16x16x32_bf16 v[28:31], v[212:215], v[84:87], v[28:31]
  buffer_load_dwordx4 v[180:183], v4, s[44:47], s14 offen offset:128 nt
  v_mfma_f32_16x16x32_bf16 v[56:59], a[100:103], v[84:87], v[56:59]
  s_waitcnt vmcnt(20)
  v_mfma_f32_16x16x32_bf16 v[28:31], v[216:219], v[88:91], v[28:31]
  buffer_load_dwordx4 v[184:187], v4, s[44:47], s14 offen offset:256 nt
  v_add_f32_dpp v36, v21, v20 quad_perm:[1,1,3,3] row_mask:0xf bank_mask:0xf
  v_add_f32_dpp v38, v23, v22 quad_perm:[1,1,3,3] row_mask:0xf bank_mask:0xf
  v_mfma_f32_16x16x32_bf16 v[56:59], a[104:107], v[88:91], v[56:59]
  v_add_f32_dpp v64, v49, v48 quad_perm:[1,1,3,3] row_mask:0xf bank_mask:0xf
  v_add_f32_dpp v66, v51, v50 quad_perm:[1,1,3,3] row_mask:0xf bank_mask:0xf
  s_waitcnt vmcnt(20)
  v_mfma_f32_16x16x32_bf16 v[28:31], v[220:223], v[92:95], v[28:31]
  buffer_load_dwordx4 v[188:191], v4, s[44:47], s14 offen offset:384 nt
  v_add_f32_dpp v37, v25, v24 quad_perm:[1,1,3,3] row_mask:0xf bank_mask:0xf
  v_add_f32_dpp v39, v27, v26 quad_perm:[1,1,3,3] row_mask:0xf bank_mask:0xf
  v_cvt_pk_bf16_f32 v37, v36, v37
  v_cvt_pk_bf16_f32 v39, v38, v39
  v_mfma_f32_16x16x32_bf16 v[56:59], a[108:111], v[92:95], v[56:59]
  v_add_f32_dpp v65, v53, v52 quad_perm:[1,1,3,3] row_mask:0xf bank_mask:0xf
  v_add_f32_dpp v67, v55, v54 quad_perm:[1,1,3,3] row_mask:0xf bank_mask:0xf
  v_cvt_pk_bf16_f32 v65, v64, v65
  v_cvt_pk_bf16_f32 v67, v66, v67
  s_waitcnt vmcnt(20)
  v_mfma_f32_16x16x32_bf16 v[32:35], v[224:227], v[80:83], 0
  buffer_load_dwordx4 v[192:195], v4, s[44:47], s14 offen offset:512 nt
  v_lshlrev_b32 v36, 16, v37
  v_lshlrev_b32 v38, 16, v39
  v_and_b32 v37, 0xffff0000, v37
  v_and_b32 v39, 0xffff0000, v39
  v_mfma_f32_16x16x32_bf16 v[60:63], a[112:115], v[80:83], 0
  v_lshlrev_b32 v64, 16, v65
  v_lshlrev_b32 v66, 16, v67
  v_and_b32 v65, 0xffff0000, v65
  v_and_b32 v67, 0xffff0000, v67
  s_waitcnt vmcnt(20)
  v_mfma_f32_16x16x32_bf16 v[32:35], v[228:231], v[84:87], v[32:35]
  buffer_load_dwordx4 v[196:199], v4, s[44:47], s14 offen offset:640 nt
  s_mov_b64 exec, s[62:63]
  ds_write_b128 v107, v[36:39] offset:4864
  s_mov_b64 exec, -1
  v_max3_f32 v6, v6, v36, v38
  v_max3_f32 v6, v6, v37, v39
  v_mfma_f32_16x16x32_bf16 v[60:63], a[116:119], v[84:87], v[60:63]
  s_mov_b64 exec, s[62:63]
  ds_write_b128 v107, v[64:67] offset:20224
  s_mov_b64 exec, -1
  v_max3_f32 v6, v6, v64, v66
  v_max3_f32 v6, v6, v65, v67
  s_waitcnt vmcnt(20)
  v_mfma_f32_16x16x32_bf16 v[32:35], v[232:235], v[88:91], v[32:35]
  buffer_load_dwordx4 v[200:203], v4, s[44:47], s14 offen offset:768 nt
  v_mfma_f32_16x16x32_bf16 v[60:63], a[120:123], v[88:91], v[60:63]
  s_waitcnt vmcnt(20)
  v_mfma_f32_16x16x32_bf16 v[32:35], v[236:239], v[92:95], v[32:35]
  buffer_load_dwordx4 v[204:207], v4, s[44:47], s14 offen offset:896 nt
  v_mfma_f32_16x16x32_bf16 v[60:63], a[124:127], v[92:95], v[60:63]
  s_or_b32 s14, s14, 0xe10000
  s_add_u32 s14, s14, 8192
  s_and_b32 s14, s14, 0xff1ee000
  v_add_u32 v107, 512, v107
  s_waitcnt vmcnt(20)
  v_mfma_f32_16x16x32_bf16 v[20:23], v[112:115], v[80:83], 0
  buffer_load_dwordx4 v[208:211], v4, s[44:47], s14 offen offset:0 nt
  v_mfma_f32_16x16x32_bf16 v[48:51], a[128:131], v[80:83], 0
  s_waitcnt vmcnt(20)
  v_mfma_f32_16x16x32_bf16 v[20:23], v[116:119], v[84:87], v[20:23]
  buffer_load_dwordx4 v[212:215], v4, s[44:47], s14 offen offset:128 nt
  v_mfma_f32_16x16x32_bf16 v[48:51], a[132:135], v[84:87], v[48:51]
  s_waitcnt vmcnt(20)
  v_mfma_f32_16x16x32_bf16 v[20:23], v[120:123], v[88:91], v[20:23]
  buffer_load_dwordx4 v[216:219], v4, s[44:47], s14 offen offset:256 nt
  v_add_f32_dpp v36, v29, v28 quad_perm:[1,1,3,3] row_mask:0xf bank_mask:0xf
  v_add_f32_dpp v38, v31, v30 quad_perm:[1,1,3,3] row_mask:0xf bank_mask:0xf
  v_mfma_f32_16x16x32_bf16 v[48:51], a[136:139], v[88:91], v[48:51]
  v_add_f32_dpp v64, v57, v56 quad_perm:[1,1,3,3] row_mask:0xf bank_mask:0xf
  v_add_f32_dpp v66, v59, v58 quad_perm:[1,1,3,3] row_mask:0xf bank_mask:0xf
  s_waitcnt vmcnt(20)
  v_mfma_f32_16x16x32_bf16 v[20:23], v[124:127], v[92:95], v[20:23]
  buffer_load_dwordx4 v[220:223], v4, s[44:47], s14 offen offset:384 nt
  v_add_f32_dpp v37, v33, v32 quad_perm:[1,1,3,3] row_mask:0xf bank_mask:0xf
  v_add_f32_dpp v39, v35, v34 quad_perm:[1,1,3,3] row_mask:0xf bank_mask:0xf
  v_cvt_pk_bf16_f32 v37, v36, v37
  v_cvt_pk_bf16_f32 v39, v38, v39
  v_mfma_f32_16x16x32_bf16 v[48:51], a[140:143], v[92:95], v[48:51]
  v_add_f32_dpp v65, v61, v60 quad_perm:[1,1,3,3] row_mask:0xf bank_mask:0xf
  v_add_f32_dpp v67, v63, v62 quad_perm:[1,1,3,3] row_mask:0xf bank_mask:0xf
  v_cvt_pk_bf16_f32 v65, v64, v65
  v_cvt_pk_bf16_f32 v67, v66, v67
  s_waitcnt vmcnt(20)
  v_mfma_f32_16x16x32_bf16 v[24:27], v[128:131], v[80:83], 0
  buffer_load_dwordx4 v[224:227], v4, s[44:47], s14 offen offset:512 nt
  v_lshlrev_b32 v36, 16, v37
  v_lshlrev_b32 v38, 16, v39
  v_and_b32 v37, 0xffff0000, v37
  v_and_b32 v39, 0xffff0000, v39
  v_mfma_f32_16x16x32_bf16 v[52:55], a[144:147], v[80:83], 0
  v_lshlrev_b32 v64, 16, v65
  v_lshlrev_b32 v66, 16, v67
  v_and_b32 v65, 0xffff0000, v65
  v_and_b32 v67, 0xffff0000, v67
  s_waitcnt vmcnt(20)
  v_mfma_f32_16x16x32_bf16 v[24:27], v[132:135], v[84:87], v[24:27]
  buffer_load_dwordx4 v[228:231], v4, s[44:47], s14 offen offset:640 nt
  s_mov_b64 exec, s[62:63]
  ds_write_b128 v107, v[36:39] offset:4480
  s_mov_b64 exec, -1
  v_max3_f32 v6, v6, v36, v38
  v_max3_f32 v6, v6, v37, v39
  v_mfma_f32_16x16x32_bf16 v[52:55], a[148:151], v[84:87], v[52:55]
  s_mov_b64 exec, s[62:63]
  ds_write_b128 v107, v[64:67] offset:19840
  s_mov_b64 exec, -1
  v_max3_f32 v6, v6, v64, v66
  v_max3_f32 v6, v6, v65, v67
  s_waitcnt vmcnt(20)
  v_mfma_f32_16x16x32_bf16 v[24:27], v[136:139], v[88:91], v[24:27]
  buffer_load_dwordx4 v[232:235], v4, s[44:47], s14 offen offset:768 nt
  v_mfma_f32_16x16x32_bf16 v[52:55], a[152:155], v[88:91], v[52:55]
  s_waitcnt vmcnt(20)
  v_mfma_f32_16x16x32_bf16 v[24:27], v[140:143], v[92:95], v[24:27]
  buffer_load_dwordx4 v[236:239], v4, s[44:47], s14 offen offset:896 nt
  v_mfma_f32_16x16x32_bf16 v[52:55], a[156:159], v[92:95], v[52:55]
  s_or_b32 s14, s14, 0xe10000
  s_add_u32 s14, s14, 8192
  s_and_b32 s14, s14, 0xff1ee000
  s_waitcnt vmcnt(20)
  v_mfma_f32_16x16x32_bf16 v[28:31], v[144:147], v[80:83], 0
  buffer_load_dwordx4 v[112:115], v4, s[44:47], s14 offen offset:0 nt
  v_mfma_f32_16x16x32_bf16 v[56:59], a[160:163], v[80:83], 0
  s_waitcnt vmcnt(20)
  v_mfma_f32_16x16x32_bf16 v[28:31], v[148:151], v[84:87], v[28:31]
  buffer_load_dwordx4 v[116:119], v4, s[44:47], s14 offen offset:128 nt
  v_mfma_f32_16x16x32_bf16 v[56:59], a[164:167], v[84:87], v[56:59]
  s_waitcnt vmcnt(20)
  v_mfma_f32_16x16x32_bf16 v[28:31], v[152:155], v[88:91], v[28:31]
  buffer_load_dwordx4 v[120:123], v4, s[44:47], s14 offen offset:256 nt
  v_add_f32_dpp v36, v21, v20 quad_perm:[1,1,3,3] row_mask:0xf bank_mask:0xf
  v_add_f32_dpp v38, v23, v22 quad_perm:[1,1,3,3] row_mask:0xf bank_mask:0xf
  v_mfma_f32_16x16x32_bf16 v[56:59], a[168:171], v[88:91], v[56:59]
  v_add_f32_dpp v64, v49, v48 quad_perm:[1,1,3,3] row_mask:0xf bank_mask:0xf
  v_add_f32_dpp v66, v51, v50 quad_perm:[1,1,3,3] row_mask:0xf bank_mask:0xf
  s_waitcnt vmcnt(20)
  v_mfma_f32_16x16x32_bf16 v[28:31], v[156:159], v[92:95], v[28:31]
  buffer_load_dwordx4 v[124:127], v4, s[44:47], s14 offen offset:384 nt
  v_add_f32_dpp v37, v25, v24 quad_perm:[1,1,3,3] row_mask:0xf bank_mask:0xf
  v_add_f32_dpp v39, v27, v26 quad_perm:[1,1,3,3] row_mask:0xf bank_mask:0xf
  v_cvt_pk_bf16_f32 v37, v36, v37
  v_cvt_pk_bf16_f32 v39, v38, v39
  v_mfma_f32_16x16x32_bf16 v[56:59], a[172:175], v[92:95], v[56:59]
  v_add_f32_dpp v65, v53, v52 quad_perm:[1,1,3,3] row_mask:0xf bank_mask:0xf
  v_add_f32_dpp v67, v55, v54 quad_perm:[1,1,3,3] row_mask:0xf bank_mask:0xf
  v_cvt_pk_bf16_f32 v65, v64, v65
  v_cvt_pk_bf16_f32 v67, v66, v67
  s_waitcnt vmcnt(20)
  v_mfma_f32_16x16x32_bf16 v[32:35], v[160:163], v[80:83], 0
  buffer_load_dwordx4 v[128:131], v4, s[44:47], s14 offen offset:512 nt
  v_lshlrev_b32 v36, 16, v37
  v_lshlrev_b32 v38, 16, v39
  v_and_b32 v37, 0xffff0000, v37
  v_and_b32 v39, 0xffff0000, v39
  v_mfma_f32_16x16x32_bf16 v[60:63], a[176:179], v[80:83], 0
  v_lshlrev_b32 v64, 16, v65
  v_lshlrev_b32 v66, 16, v67
  v_and_b32 v65, 0xffff0000, v65
  v_and_b32 v67, 0xffff0000, v67
  s_waitcnt vmcnt(20)
  v_mfma_f32_16x16x32_bf16 v[32:35], v[164:167], v[84:87], v[32:35]
  buffer_load_dwordx4 v[132:135], v4, s[44:47], s14 offen offset:640 nt
  s_mov_b64 exec, s[62:63]
  ds_write_b128 v107, v[36:39] offset:4608
  s_mov_b64 exec, -1
  v_max3_f32 v6, v6, v36, v38
  v_max3_f32 v6, v6, v37, v39
  v_mfma_f32_16x16x32_bf16 v[60:63], a[180:183], v[84:87], v[60:63]
  s_mov_b64 exec, s[62:63]
  ds_write_b128 v107, v[64:67] offset:19968
  s_mov_b64 exec, -1
  v_max3_f32 v6, v6, v64, v66
  v_max3_f32 v6, v6, v65, v67
  s_waitcnt vmcnt(20)
  v_mfma_f32_16x16x32_bf16 v[32:35], v[168:171], v[88:91], v[32:35]
  buffer_load_dwordx4 v[136:139], v4, s[44:47], s14 offen offset:768 nt
  v_mfma_f32_16x16x32_bf16 v[60:63], a[184:187], v[88:91], v[60:63]
  s_waitcnt vmcnt(20)
  v_mfma_f32_16x16x32_bf16 v[32:35], v[172:175], v[92:95], v[32:35]
  buffer_load_dwordx4 v[140:143], v4, s[44:47], s14 offen offset:896 nt
  v_mfma_f32_16x16x32_bf16 v[60:63], a[188:191], v[92:95], v[60:63]
  s_or_b32 s14, s14, 0xe10000
  s_add_u32 s14, s14, 8192
  s_and_b32 s14, s14, 0xff1ee000
  s_waitcnt vmcnt(20)
  v_mfma_f32_16x16x32_bf16 v[20:23], v[176:179], v[80:83], 0
  buffer_load_dwordx4 v[144:147], v4, s[44:47], s14 offen offset:0 nt
  v_mfma_f32_16x16x32_bf16 v[48:51], a[192:195], v[80:83], 0
  s_waitcnt vmcnt(20)
  v_mfma_f32_16x16x32_bf16 v[20:23], v[180:183], v[84:87], v[20:23]
  buffer_load_dwordx4 v[148:151], v4, s[44:47], s14 offen offset:128 nt
  v_mfma_f32_16x16x32_bf16 v[48:51], a[196:199], v[84:87], v[48:51]
  s_waitcnt vmcnt(20)
  v_mfma_f32_16x16x32_bf16 v[20:23], v[184:187], v[88:91], v[20:23]
  buffer_load_dwordx4 v[152:155], v4, s[44:47], s14 offen offset:256 nt
  v_add_f32_dpp v36, v29, v28 quad_perm:[1,1,3,3] row_mask:0xf bank_mask:0xf
  v_add_f32_dpp v38, v31, v30 quad_perm:[1,1,3,3] row_mask:0xf bank_mask:0xf
  v_mfma_f32_16x16x32_bf16 v[48:51], a[200:203], v[88:91], v[48:51]
  v_add_f32_dpp v64, v57, v56 quad_perm:[1,1,3,3] row_mask:0xf bank_mask:0xf
  v_add_f32_dpp v66, v59, v58 quad_perm:[1,1,3,3] row_mask:0xf bank_mask:0xf
  s_waitcnt vmcnt(20)
  v_mfma_f32_16x16x32_bf16 v[20:23], v[188:191], v[92:95], v[20:23]
  buffer_load_dwordx4 v[156:159], v4, s[44:47], s14 offen offset:384 nt
  v_add_f32_dpp v37, v33, v32 quad_perm:[1,1,3,3] row_mask:0xf bank_mask:0xf
  v_add_f32_dpp v39, v35, v34 quad_perm:[1,1,3,3] row_mask:0xf bank_mask:0xf
  v_cvt_pk_bf16_f32 v37, v36, v37
  v_cvt_pk_bf16_f32 v39, v38, v39
  v_mfma_f32_16x16x32_bf16 v[48:51], a[204:207], v[92:95], v[48:51]
  v_add_f32_dpp v65, v61, v60 quad_perm:[1,1,3,3] row_mask:0xf bank_mask:0xf
  v_add_f32_dpp v67, v63, v62 quad_perm:[1,1,3,3] row_mask:0xf bank_mask:0xf
  v_cvt_pk_bf16_f32 v65, v64, v65
  v_cvt_pk_bf16_f32 v67, v66, v67
  s_waitcnt vmcnt(20)
  v_mfma_f32_16x16x32_bf16 v[24:27], v[192:195], v[80:83], 0
  buffer_load_dwordx4 v[160:163], v4, s[44:47], s14 offen offset:512 nt
  v_lshlrev_b32 v36, 16, v37
  v_lshlrev_b32 v38, 16, v39
  v_and_b32 v37, 0xffff0000, v37
  v_and_b32 v39, 0xffff0000, v39
  v_mfma_f32_16x16x32_bf16 v[52:55], a[208:211], v[80:83], 0
  v_lshlrev_b32 v64, 16, v65
  v_lshlrev_b32 v66, 16, v67
  v_and_b32 v65, 0xffff0000, v65
  v_and_b32 v67, 0xffff0000, v67
  s_waitcnt vmcnt(20)
  v_mfma_f32_16x16x32_bf16 v[24:27], v[196:199], v[84:87], v[24:27]
  buffer_load_dwordx4 v[164:167], v4, s[44:47], s14 offen offset:640 nt
  s_mov_b64 exec, s[62:63]
  ds_write_b128 v107, v[36:39] offset:4736
  s_mov_b64 exec, -1
  v_max3_f32 v6, v6, v36, v38
  v_max3_f32 v6, v6, v37, v39
  v_mfma_f32_16x16x32_bf16 v[52:55], a[212:215], v[84:87], v[52:55]
  s_mov_b64 exec, s[62:63]
  ds_write_b128 v107, v[64:67] offset:20096
  s_mov_b64 exec, -1
  v_max3_f32 v6, v6, v64, v66
  v_max3_f32 v6, v6, v65, v67
  s_waitcnt vmcnt(20)
  v_mfma_f32_16x16x32_bf16 v[24:27], v[200:203], v[88:91], v[24:27]
  buffer_load_dwordx4 v[168:171], v4, s[44:47], s14 offen offset:768 nt
  v_mfma_f32_16x16x32_bf16 v[52:55], a[216:219], v[88:91], v[52:55]
  s_waitcnt vmcnt(20)
  v_mfma_f32_16x16x32_bf16 v[24:27], v[204:207], v[92:95], v[24:27]
  buffer_load_dwordx4 v[172:175], v4, s[44:47], s14 offen offset:896 nt
  v_mfma_f32_16x16x32_bf16 v[52:55], a[220:223], v[92:95], v[52:55]
  s_or_b32 s14, s14, 0xe10000
  s_add_u32 s14, s14, 8192
  s_and_b32 s14, s14, 0xff1ee000
  s_waitcnt vmcnt(20)
  v_mfma_f32_16x16x32_bf16 v[28:31], v[208:211], v[80:83], 0
  buffer_load_dwordx4 v[176:179], v4, s[44:47], s14 offen offset:0 nt
  v_mfma_f32_16x16x32_bf16 v[56:59], a[224:227], v[80:83], 0
  s_waitcnt vmcnt(20)
  v_mfma_f32_16x16x32_bf16 v[28:31], v[212:215], v[84:87], v[28:31]
  buffer_load_dwordx4 v[180:183], v4, s[44:47], s14 offen offset:128 nt
  v_mfma_f32_16x16x32_bf16 v[56:59], a[228:231], v[84:87], v[56:59]
  s_waitcnt vmcnt(20)
  v_mfma_f32_16x16x32_bf16 v[28:31], v[216:219], v[88:91], v[28:31]
  buffer_load_dwordx4 v[184:187], v4, s[44:47], s14 offen offset:256 nt
  v_add_f32_dpp v36, v21, v20 quad_perm:[1,1,3,3] row_mask:0xf bank_mask:0xf
  v_add_f32_dpp v38, v23, v22 quad_perm:[1,1,3,3] row_mask:0xf bank_mask:0xf
  v_mfma_f32_16x16x32_bf16 v[56:59], a[232:235], v[88:91], v[56:59]
  v_add_f32_dpp v64, v49, v48 quad_perm:[1,1,3,3] row_mask:0xf bank_mask:0xf
  v_add_f32_dpp v66, v51, v50 quad_perm:[1,1,3,3] row_mask:0xf bank_mask:0xf
  s_waitcnt vmcnt(20)
  v_mfma_f32_16x16x32_bf16 v[28:31], v[220:223], v[92:95], v[28:31]
  buffer_load_dwordx4 v[188:191], v4, s[44:47], s14 offen offset:384 nt
  v_add_f32_dpp v37, v25, v24 quad_perm:[1,1,3,3] row_mask:0xf bank_mask:0xf
  v_add_f32_dpp v39, v27, v26 quad_perm:[1,1,3,3] row_mask:0xf bank_mask:0xf
  v_cvt_pk_bf16_f32 v37, v36, v37
  v_cvt_pk_bf16_f32 v39, v38, v39
  v_mfma_f32_16x16x32_bf16 v[56:59], a[236:239], v[92:95], v[56:59]
  v_add_f32_dpp v65, v53, v52 quad_perm:[1,1,3,3] row_mask:0xf bank_mask:0xf
  v_add_f32_dpp v67, v55, v54 quad_perm:[1,1,3,3] row_mask:0xf bank_mask:0xf
  v_cvt_pk_bf16_f32 v65, v64, v65
  v_cvt_pk_bf16_f32 v67, v66, v67
  s_waitcnt vmcnt(20)
  v_mfma_f32_16x16x32_bf16 v[32:35], v[224:227], v[80:83], 0
  buffer_load_dwordx4 v[192:195], v4, s[44:47], s14 offen offset:512 nt
  v_lshlrev_b32 v36, 16, v37
  v_lshlrev_b32 v38, 16, v39
  v_and_b32 v37, 0xffff0000, v37
  v_and_b32 v39, 0xffff0000, v39
  v_mfma_f32_16x16x32_bf16 v[60:63], a[240:243], v[80:83], 0
  v_lshlrev_b32 v64, 16, v65
  v_lshlrev_b32 v66, 16, v67
  v_and_b32 v65, 0xffff0000, v65
  v_and_b32 v67, 0xffff0000, v67
  s_waitcnt vmcnt(20)
  v_mfma_f32_16x16x32_bf16 v[32:35], v[228:231], v[84:87], v[32:35]
  buffer_load_dwordx4 v[196:199], v4, s[44:47], s14 offen offset:640 nt
  s_mov_b64 exec, s[62:63]
  ds_write_b128 v107, v[36:39] offset:4864
  s_mov_b64 exec, -1
  v_max3_f32 v6, v6, v36, v38
  v_max3_f32 v6, v6, v37, v39
  v_mfma_f32_16x16x32_bf16 v[60:63], a[244:247], v[84:87], v[60:63]
  s_mov_b64 exec, s[62:63]
  ds_write_b128 v107, v[64:67] offset:20224
  s_mov_b64 exec, -1
  v_max3_f32 v6, v6, v64, v66
  v_max3_f32 v6, v6, v65, v67
  s_waitcnt vmcnt(20)
  v_mfma_f32_16x16x32_bf16 v[32:35], v[232:235], v[88:91], v[32:35]
  buffer_load_dwordx4 v[200:203], v4, s[44:47], s14 offen offset:768 nt
  v_mfma_f32_16x16x32_bf16 v[60:63], a[248:251], v[88:91], v[60:63]
  s_waitcnt vmcnt(20)
  v_mfma_f32_16x16x32_bf16 v[32:35], v[236:239], v[92:95], v[32:35]
  buffer_load_dwordx4 v[204:207], v4, s[44:47], s14 offen offset:896 nt
  v_mfma_f32_16x16x32_bf16 v[60:63], a[252:255], v[92:95], v[60:63]
  s_or_b32 s14, s14, 0xe10000
  s_add_u32 s14, s14, 8192
  s_and_b32 s14, s14, 0xff1ee000
  v_add_u32 v107, 512, v107
  s_mov_b64 exec, 1
  buffer_load_dword v242, off, s[48:51], 0 nt
  s_mov_b64 exec, -1
  v_mov_b32 v9, 1
  ds_write_b32 v15, v9 offset:1028
  v_add_f32_dpp v64, v57, v56 quad_perm:[1,1,3,3] row_mask:0xf bank_mask:0xf
  v_add_f32_dpp v66, v59, v58 quad_perm:[1,1,3,3] row_mask:0xf bank_mask:0xf
  v_add_f32_dpp v65, v61, v60 quad_perm:[1,1,3,3] row_mask:0xf bank_mask:0xf
  v_add_f32_dpp v67, v63, v62 quad_perm:[1,1,3,3] row_mask:0xf bank_mask:0xf
  v_cvt_pk_bf16_f32 v65, v64, v65
  v_cvt_pk_bf16_f32 v67, v66, v67
  v_lshlrev_b32 v64, 16, v65
  v_lshlrev_b32 v66, 16, v67
  v_and_b32 v65, 0xffff0000, v65
  v_and_b32 v67, 0xffff0000, v67
  s_mov_b64 exec, s[62:63]
  ds_write_b128 v107, v[64:67] offset:19840
  s_mov_b64 exec, -1
  v_max3_f32 v6, v6, v64, v66
  v_max3_f32 v6, v6, v65, v67
  s_mov_b32 s11, 27
  v_mov_b32 v243, 0
  s_branch L_loop1_1
L_loop1_0:
  s_waitcnt vmcnt(18)
  v_mfma_f32_16x16x32_bf16 v[20:23], v[112:115], v[80:83], 0
  buffer_load_dwordx4 v[208:211], v4, s[44:47], s14 offen offset:0 nt
  s_waitcnt vmcnt(18)
  v_mfma_f32_16x16x32_bf16 v[20:23], v[116:119], v[84:87], v[20:23]
  buffer_load_dwordx4 v[212:215], v4, s[44:47], s14 offen offset:128 nt
  s_waitcnt vmcnt(18)
  v_mfma_f32_16x16x32_bf16 v[20:23], v[120:123], v[88:91], v[20:23]
  buffer_load_dwordx4 v[216:219], v4, s[44:47], s14 offen offset:256 nt
  v_add_f32_dpp v36, v29, v28 quad_perm:[1,1,3,3] row_mask:0xf bank_mask:0xf
  v_add_f32_dpp v38, v31, v30 quad_perm:[1,1,3,3] row_mask:0xf bank_mask:0xf
  s_waitcnt vmcnt(18)
  v_mfma_f32_16x16x32_bf16 v[20:23], v[124:127], v[92:95], v[20:23]
  buffer_load_dwordx4 v[220:223], v4, s[44:47], s14 offen offset:384 nt
  v_add_f32_dpp v37, v33, v32 quad_perm:[1,1,3,3] row_mask:0xf bank_mask:0xf
  v_add_f32_dpp v39, v35, v34 quad_perm:[1,1,3,3] row_mask:0xf bank_mask:0xf
  v_cvt_pk_bf16_f32 v37, v36, v37
  v_cvt_pk_bf16_f32 v39, v38, v39
  s_waitcnt vmcnt(18)
  v_mfma_f32_16x16x32_bf16 v[24:27], v[128:131], v[80:83], 0
  buffer_load_dwordx4 v[224:227], v4, s[44:47], s14 offen offset:512 nt
  v_lshlrev_b32 v36, 16, v37
  v_lshlrev_b32 v38, 16, v39
  v_and_b32 v37, 0xffff0000, v37
  v_and_b32 v39, 0xffff0000, v39
  s_waitcnt vmcnt(18)
  v_mfma_f32_16x16x32_bf16 v[24:27], v[132:135], v[84:87], v[24:27]
  buffer_load_dwordx4 v[228:231], v4, s[44:47], s14 offen offset:640 nt
  s_mov_b64 exec, s[62:63]
  ds_write_b128 v107, v[36:39] offset:4480
  s_mov_b64 exec, -1
  v_max3_f32 v6, v6, v36, v38
  v_max3_f32 v6, v6, v37, v39
  s_waitcnt vmcnt(18)
  v_mfma_f32_16x16x32_bf16 v[24:27], v[136:139], v[88:91], v[24:27]
  buffer_load_dwordx4 v[232:235], v4, s[44:47], s14 offen offset:768 nt
  s_waitcnt vmcnt(18)
  v_mfma_f32_16x16x32_bf16 v[24:27], v[140:143], v[92:95], v[24:27]
  buffer_load_dwordx4 v[236:239], v4, s[44:47], s14 offen offset:896 nt
  s_or_b32 s14, s14, 0xe10000
  s_add_u32 s14, s14, 8192
  s_and_b32 s14, s14, 0xff1ee000
  s_waitcnt vmcnt(18)
  v_mfma_f32_16x16x32_bf16 v[28:31], v[144:147], v[80:83], 0
  buffer_load_dwordx4 v[112:115], v4, s[44:47], s14 offen offset:0 nt
  s_waitcnt vmcnt(18)
  v_mfma_f32_16x16x32_bf16 v[28:31], v[148:151], v[84:87], v[28:31]
  buffer_load_dwordx4 v[116:119], v4, s[44:47], s14 offen offset:128 nt
  s_waitcnt vmcnt(18)
  v_mfma_f32_16x16x32_bf16 v[28:31], v[152:155], v[88:91], v[28:31]
  buffer_load_dwordx4 v[120:123], v4, s[44:47], s14 offen offset:256 nt
  v_add_f32_dpp v36, v21, v20 quad_perm:[1,1,3,3] row_mask:0xf bank_mask:0xf
  v_add_f32_dpp v38, v23, v22 quad_perm:[1,1,3,3] row_mask:0xf bank_mask:0xf
  s_waitcnt vmcnt(18)
  v_mfma_f32_16x16x32_bf16 v[28:31], v[156:159], v[92:95], v[28:31]
  buffer_load_dwordx4 v[124:127], v4, s[44:47], s14 offen offset:384 nt
  v_add_f32_dpp v37, v25, v24 quad_perm:[1,1,3,3] row_mask:0xf bank_mask:0xf
  v_add_f32_dpp v39, v27, v26 quad_perm:[1,1,3,3] row_mask:0xf bank_mask:0xf
  v_cvt_pk_bf16_f32 v37, v36, v37
  v_cvt_pk_bf16_f32 v39, v38, v39
  s_waitcnt vmcnt(18)
  v_mfma_f32_16x16x32_bf16 v[32:35], v[160:163], v[80:83], 0
  buffer_load_dwordx4 v[128:131], v4, s[44:47], s14 offen offset:512 nt
  v_lshlrev_b32 v36, 16, v37
  v_lshlrev_b32 v38, 16, v39
  v_and_b32 v37, 0xffff0000, v37
  v_and_b32 v39, 0xffff0000, v39
  s_waitcnt vmcnt(18)
  v_mfma_f32_16x16x32_bf16 v[32:35], v[164:167], v[84:87], v[32:35]
  buffer_load_dwordx4 v[132:135], v4, s[44:47], s14 offen offset:640 nt
  s_mov_b64 exec, s[62:63]
  ds_write_b128 v107, v[36:39] offset:4608
  s_mov_b64 exec, -1
  v_max3_f32 v6, v6, v36, v38
  v_max3_f32 v6, v6, v37, v39
  s_waitcnt vmcnt(18)
  v_mfma_f32_16x16x32_bf16 v[32:35], v[168:171], v[88:91], v[32:35]
  buffer_load_dwordx4 v[136:139], v4, s[44:47], s14 offen offset:768 nt
  s_waitcnt vmcnt(18)
  v_mfma_f32_16x16x32_bf16 v[32:35], v[172:175], v[92:95], v[32:35]
  buffer_load_dwordx4 v[140:143], v4, s[44:47], s14 offen offset:896 nt
  s_or_b32 s14, s14, 0xe10000
  s_add_u32 s14, s14, 8192
  s_and_b32 s14, s14, 0xff1ee000
  s_waitcnt vmcnt(18)
  v_mfma_f32_16x16x32_bf16 v[20:23], v[176:179], v[80:83], 0
  buffer_load_dwordx4 v[144:147], v4, s[44:47], s14 offen offset:0 nt
  s_waitcnt vmcnt(18)
  v_mfma_f32_16x16x32_bf16 v[20:23], v[180:183], v[84:87], v[20:23]
  buffer_load_dwordx4 v[148:151], v4, s[44:47], s14 offen offset:128 nt
  s_waitcnt vmcnt(18)
  v_mfma_f32_16x16x32_bf16 v[20:23], v[184:187], v[88:91], v[20:23]
  buffer_load_dwordx4 v[152:155], v4, s[44:47], s14 offen offset:256 nt
  v_add_f32_dpp v36, v29, v28 quad_perm:[1,1,3,3] row_mask:0xf bank_mask:0xf
  v_add_f32_dpp v38, v31, v30 quad_perm:[1,1,3,3] row_mask:0xf bank_mask:0xf
  s_waitcnt vmcnt(18)
  v_mfma_f32_16x16x32_bf16 v[20:23], v[188:191], v[92:95], v[20:23]
  buffer_load_dwordx4 v[156:159], v4, s[44:47], s14 offen offset:384 nt
  v_add_f32_dpp v37, v33, v32 quad_perm:[1,1,3,3] row_mask:0xf bank_mask:0xf
  v_add_f32_dpp v39, v35, v34 quad_perm:[1,1,3,3] row_mask:0xf bank_mask:0xf
  v_cvt_pk_bf16_f32 v37, v36, v37
  v_cvt_pk_bf16_f32 v39, v38, v39
  s_waitcnt vmcnt(18)
  v_mfma_f32_16x16x32_bf16 v[24:27], v[192:195], v[80:83], 0
  buffer_load_dwordx4 v[160:163], v4, s[44:47], s14 offen offset:512 nt
  v_lshlrev_b32 v36, 16, v37
  v_lshlrev_b32 v38, 16, v39
  v_and_b32 v37, 0xffff0000, v37
  v_and_b32 v39, 0xffff0000, v39
  s_waitcnt vmcnt(18)
  v_mfma_f32_16x16x32_bf16 v[24:27], v[196:199], v[84:87], v[24:27]
  buffer_load_dwordx4 v[164:167], v4, s[44:47], s14 offen offset:640 nt
  s_mov_b64 exec, s[62:63]
  ds_write_b128 v107, v[36:39] offset:4736
  s_mov_b64 exec, -1
  v_max3_f32 v6, v6, v36, v38
  v_max3_f32 v6, v6, v37, v39
  s_waitcnt vmcnt(18)
  v_mfma_f32_16x16x32_bf16 v[24:27], v[200:203], v[88:91], v[24:27]
  buffer_load_dwordx4 v[168:171], v4, s[44:47], s14 offen offset:768 nt
  s_waitcnt vmcnt(18)
  v_mfma_f32_16x16x32_bf16 v[24:27], v[204:207], v[92:95], v[24:27]
  buffer_load_dwordx4 v[172:175], v4, s[44:47], s14 offen offset:896 nt
  s_or_b32 s14, s14, 0xe10000
  s_add_u32 s14, s14, 8192
  s_and_b32 s14, s14, 0xff1ee000
  s_waitcnt vmcnt(18)
  v_mfma_f32_16x16x32_bf16 v[28:31], v[208:211], v[80:83], 0
  buffer_load_dwordx4 v[176:179], v4, s[44:47], s14 offen offset:0 nt
  v_add_u32 v243, 1, v243
  ds_write_b32 v15, v243 offset:1032
  ds_read_b32 v248, v15 offset:1036
  s_waitcnt vmcnt(18)
  v_mfma_f32_16x16x32_bf16 v[28:31], v[212:215], v[84:87], v[28:31]
  buffer_load_dwordx4 v[180:183], v4, s[44:47], s14 offen offset:128 nt
  s_waitcnt vmcnt(18)
  v_mfma_f32_16x16x32_bf16 v[28:31], v[216:219], v[88:91], v[28:31]
  buffer_load_dwordx4 v[184:187], v4, s[44:47], s14 offen offset:256 nt
  v_add_f32_dpp v36, v21, v20 quad_perm:[1,1,3,3] row_mask:0xf bank_mask:0xf
  v_add_f32_dpp v38, v23, v22 quad_perm:[1,1,3,3] row_mask:0xf bank_mask:0xf
  s_waitcnt vmcnt(18)
  v_mfma_f32_16x16x32_bf16 v[28:31], v[220:223], v[92:95], v[28:31]
  buffer_load_dwordx4 v[188:191], v4, s[44:47], s14 offen offset:384 nt
  v_add_f32_dpp v37, v25, v24 quad_perm:[1,1,3,3] row_mask:0xf bank_mask:0xf
  v_add_f32_dpp v39, v27, v26 quad_perm:[1,1,3,3] row_mask:0xf bank_mask:0xf
  v_cvt_pk_bf16_f32 v37, v36, v37
  v_cvt_pk_bf16_f32 v39, v38, v39
  s_waitcnt vmcnt(18)
  v_mfma_f32_16x16x32_bf16 v[32:35], v[224:227], v[80:83], 0
  buffer_load_dwordx4 v[192:195], v4, s[44:47], s14 offen offset:512 nt
  v_lshlrev_b32 v36, 16, v37
  v_lshlrev_b32 v38, 16, v39
  v_and_b32 v37, 0xffff0000, v37
  v_and_b32 v39, 0xffff0000, v39
  s_waitcnt vmcnt(18)
  v_mfma_f32_16x16x32_bf16 v[32:35], v[228:231], v[84:87], v[32:35]
  buffer_load_dwordx4 v[196:199], v4, s[44:47], s14 offen offset:640 nt
  s_mov_b64 exec, s[62:63]
  ds_write_b128 v107, v[36:39] offset:4864
  s_mov_b64 exec, -1
  v_max3_f32 v6, v6, v36, v38
  v_max3_f32 v6, v6, v37, v39
  s_waitcnt vmcnt(18)
  v_mfma_f32_16x16x32_bf16 v[32:35], v[232:235], v[88:91], v[32:35]
  buffer_load_dwordx4 v[200:203], v4, s[44:47], s14 offen offset:768 nt
  s_waitcnt vmcnt(18)
  v_mfma_f32_16x16x32_bf16 v[32:35], v[236:239], v[92:95], v[32:35]
  buffer_load_dwordx4 v[204:207], v4, s[44:47], s14 offen offset:896 nt
  s_or_b32 s14, s14, 0xe10000
  s_add_u32 s14, s14, 8192
  s_and_b32 s14, s14, 0xff1ee000
  s_waitcnt lgkmcnt(1)
  v_add_u32 v107, 512, v107
  s_sub_u32 s11, s11, 1
  s_cmp_eq_u32 s11, 0
  s_cbranch_scc1 L_loop1_done
  v_readfirstlane_b32 s15, v248
  s_nop 3
  s_cmp_eq_u32 s15, 0
  s_cbranch_scc1 L_loop1_0
  s_cmp_eq_u32 s15, 1
  s_cbranch_scc1 L_loop1_1
  s_cmp_eq_u32 s15, 2
  s_cbranch_scc1 L_loop1_2
  s_branch L_loop1_3
L_loop1_1:
  s_waitcnt vmcnt(20)
  v_mfma_f32_16x16x32_bf16 v[20:23], v[112:115], v[80:83], 0
  buffer_load_dwordx4 v[208:211], v4, s[44:47], s14 offen offset:0 nt
  s_waitcnt vmcnt(20)
  v_mfma_f32_16x16x32_bf16 v[20:23], v[116:119], v[84:87], v[20:23]
  buffer_load_dwordx4 v[212:215], v4, s[44:47], s14 offen offset:128 nt
  s_waitcnt vmcnt(20)
  v_mfma_f32_16x16x32_bf16 v[20:23], v[120:123], v[88:91], v[20:23]
  buffer_load_dwordx4 v[216:219], v4, s[44:47], s14 offen offset:256 nt
  v_add_f32_dpp v36, v29, v28 quad_perm:[1,1,3,3] row_mask:0xf bank_mask:0xf
  v_add_f32_dpp v38, v31, v30 quad_perm:[1,1,3,3] row_mask:0xf bank_mask:0xf
  s_waitcnt vmcnt(20)
  v_mfma_f32_16x16x32_bf16 v[20:23], v[124:127], v[92:95], v[20:23]
  buffer_load_dwordx4 v[220:223], v4, s[44:47], s14 offen offset:384 nt
  v_add_f32_dpp v37, v33, v32 quad_perm:[1,1,3,3] row_mask:0xf bank_mask:0xf
  v_add_f32_dpp v39, v35, v34 quad_perm:[1,1,3,3] row_mask:0xf bank_mask:0xf
  v_cvt_pk_bf16_f32 v37, v36, v37
  v_cvt_pk_bf16_f32 v39, v38, v39
  s_waitcnt vmcnt(20)
  v_mfma_f32_16x16x32_bf16 v[24:27], v[128:131], v[80:83], 0
  buffer_load_dwordx4 v[224:227], v4, s[44:47], s14 offen offset:512 nt
  v_lshlrev_b32 v36, 16, v37
  v_lshlrev_b32 v38, 16, v39
  v_and_b32 v37, 0xffff0000, v37
  v_and_b32 v39, 0xffff0000, v39
  s_waitcnt vmcnt(20)
  v_mfma_f32_16x16x32_bf16 v[24:27], v[132:135], v[84:87], v[24:27]
  buffer_load_dwordx4 v[228:231], v4, s[44:47], s14 offen offset:640 nt
  s_mov_b64 exec, s[62:63]
  ds_write_b128 v107, v[36:39] offset:4480
  s_mov_b64 exec, -1
  v_max3_f32 v6, v6, v36, v38
  v_max3_f32 v6, v6, v37, v39
  s_waitcnt vmcnt(20)
  v_mfma_f32_16x16x32_bf16 v[24:27], v[136:139], v[88:91], v[24:27]
  buffer_load_dwordx4 v[232:235], v4, s[44:47], s14 offen offset:768 nt
  s_waitcnt vmcnt(20)
  v_mfma_f32_16x16x32_bf16 v[24:27], v[140:143], v[92:95], v[24:27]
  buffer_load_dwordx4 v[236:239], v4, s[44:47], s14 offen offset:896 nt
  s_or_b32 s14, s14, 0xe10000
  s_add_u32 s14, s14, 8192
  s_and_b32 s14, s14, 0xff1ee000
  s_waitcnt vmcnt(20)
  v_mfma_f32_16x16x32_bf16 v[28:31], v[144:147], v[80:83], 0
  buffer_load_dwordx4 v[112:115], v4, s[44:47], s14 offen offset:0 nt
  s_waitcnt vmcnt(20)
  v_mfma_f32_16x16x32_bf16 v[28:31], v[148:151], v[84:87], v[28:31]
  buffer_load_dwordx4 v[116:119], v4, s[44:47], s14 offen offset:128 nt
  s_waitcnt vmcnt(20)
  v_mfma_f32_16x16x32_bf16 v[28:31], v[152:155], v[88:91], v[28:31]
  buffer_load_dwordx4 v[120:123], v4, s[44:47], s14 offen offset:256 nt
  v_add_f32_dpp v36, v21, v20 quad_perm:[1,1,3,3] row_mask:0xf bank_mask:0xf
  v_add_f32_dpp v38, v23, v22 quad_perm:[1,1,3,3] row_mask:0xf bank_mask:0xf
  s_waitcnt vmcnt(20)
  v_mfma_f32_16x16x32_bf16 v[28:31], v[156:159], v[92:95], v[28:31]
  buffer_load_dwordx4 v[124:127], v4, s[44:47], s14 offen offset:384 nt
  v_add_f32_dpp v37, v25, v24 quad_perm:[1,1,3,3] row_mask:0xf bank_mask:0xf
  v_add_f32_dpp v39, v27, v26 quad_perm:[1,1,3,3] row_mask:0xf bank_mask:0xf
  v_cvt_pk_bf16_f32 v37, v36, v37
  v_cvt_pk_bf16_f32 v39, v38, v39
  s_waitcnt vmcnt(20)
  v_mfma_f32_16x16x32_bf16 v[32:35], v[160:163], v[80:83], 0
  buffer_load_dwordx4 v[128:131], v4, s[44:47], s14 offen offset:512 nt
  v_lshlrev_b32 v36, 16, v37
  v_lshlrev_b32 v38, 16, v39
  v_and_b32 v37, 0xffff0000, v37
  v_and_b32 v39, 0xffff0000, v39
  s_waitcnt vmcnt(20)
  v_mfma_f32_16x16x32_bf16 v[32:35], v[164:167], v[84:87], v[32:35]
  buffer_load_dwordx4 v[132:135], v4, s[44:47], s14 offen offset:640 nt
  s_mov_b64 exec, s[62:63]
  ds_write_b128 v107, v[36:39] offset:4608
  s_mov_b64 exec, -1
  v_max3_f32 v6, v6, v36, v38
  v_max3_f32 v6, v6, v37, v39
  s_waitcnt vmcnt(20)
  v_mfma_f32_16x16x32_bf16 v[32:35], v[168:171], v[88:91], v[32:35]
  buffer_load_dwordx4 v[136:139], v4, s[44:47], s14 offen offset:768 nt
  s_waitcnt vmcnt(20)
  v_mfma_f32_16x16x32_bf16 v[32:35], v[172:175], v[92:95], v[32:35]
  buffer_load_dwordx4 v[140:143], v4, s[44:47], s14 offen offset:896 nt
  s_or_b32 s14, s14, 0xe10000
  s_add_u32 s14, s14, 8192
  s_and_b32 s14, s14, 0xff1ee000
  s_waitcnt vmcnt(20)
  v_mfma_f32_16x16x32_bf16 v[20:23], v[176:179], v[80:83], 0
  buffer_load_dwordx4 v[144:147], v4, s[44:47], s14 offen offset:0 nt
  s_waitcnt vmcnt(20)
  v_mfma_f32_16x16x32_bf16 v[20:23], v[180:183], v[84:87], v[20:23]
  buffer_load_dwordx4 v[148:151], v4, s[44:47], s14 offen offset:128 nt
  s_waitcnt vmcnt(20)
  v_mfma_f32_16x16x32_bf16 v[20:23], v[184:187], v[88:91], v[20:23]
  buffer_load_dwordx4 v[152:155], v4, s[44:47], s14 offen offset:256 nt
  v_add_f32_dpp v36, v29, v28 quad_perm:[1,1,3,3] row_mask:0xf bank_mask:0xf
  v_add_f32_dpp v38, v31, v30 quad_perm:[1,1,3,3] row_mask:0xf bank_mask:0xf
  s_waitcnt vmcnt(20)
  v_mfma_f32_16x16x32_bf16 v[20:23], v[188:191], v[92:95], v[20:23]
  buffer_load_dwordx4 v[156:159], v4, s[44:47], s14 offen offset:384 nt
  v_add_f32_dpp v37, v33, v32 quad_perm:[1,1,3,3] row_mask:0xf bank_mask:0xf
  v_add_f32_dpp v39, v35, v34 quad_perm:[1,1,3,3] row_mask:0xf bank_mask:0xf
  v_cvt_pk_bf16_f32 v37, v36, v37
  v_cvt_pk_bf16_f32 v39, v38, v39
  s_waitcnt vmcnt(20)
  v_mfma_f32_16x16x32_bf16 v[24:27], v[192:195], v[80:83], 0
  buffer_load_dwordx4 v[160:163], v4, s[44:47], s14 offen offset:512 nt
  v_lshlrev_b32 v36, 16, v37
  v_lshlrev_b32 v38, 16, v39
  v_and_b32 v37, 0xffff0000, v37
  v_and_b32 v39, 0xffff0000, v39
  s_waitcnt vmcnt(20)
  v_mfma_f32_16x16x32_bf16 v[24:27], v[196:199], v[84:87], v[24:27]
  buffer_load_dwordx4 v[164:167], v4, s[44:47], s14 offen offset:640 nt
  s_mov_b64 exec, s[62:63]
  ds_write_b128 v107, v[36:39] offset:4736
  s_mov_b64 exec, -1
  v_max3_f32 v6, v6, v36, v38
  v_max3_f32 v6, v6, v37, v39
  s_waitcnt vmcnt(20)
  v_mfma_f32_16x16x32_bf16 v[24:27], v[200:203], v[88:91], v[24:27]
  buffer_load_dwordx4 v[168:171], v4, s[44:47], s14 offen offset:768 nt
  s_waitcnt vmcnt(20)
  v_mfma_f32_16x16x32_bf16 v[24:27], v[204:207], v[92:95], v[24:27]
  buffer_load_dwordx4 v[172:175], v4, s[44:47], s14 offen offset:896 nt
  s_or_b32 s14, s14, 0xe10000
  s_add_u32 s14, s14, 8192
  s_and_b32 s14, s14, 0xff1ee000
  s_waitcnt vmcnt(20)
  v_mfma_f32_16x16x32_bf16 v[28:31], v[208:211], v[80:83], 0
  buffer_load_dwordx4 v[176:179], v4, s[44:47], s14 offen offset:0 nt
  v_add_u32 v243, 1, v243
  ds_write_b32 v15, v243 offset:1032
  ds_read_b32 v248, v15 offset:1036
  s_waitcnt vmcnt(20)
  v_mfma_f32_16x16x32_bf16 v[28:31], v[212:215], v[84:87], v[28:31]
  buffer_load_dwordx4 v[180:183], v4, s[44:47], s14 offen offset:128 nt
  s_waitcnt vmcnt(20)
  v_mfma_f32_16x16x32_bf16 v[28:31], v[216:219], v[88:91], v[28:31]
  buffer_load_dwordx4 v[184:187], v4, s[44:47], s14 offen offset:256 nt
  v_add_f32_dpp v36, v21, v20 quad_perm:[1,1,3,3] row_mask:0xf bank_mask:0xf
  v_add_f32_dpp v38, v23, v22 quad_perm:[1,1,3,3] row_mask:0xf bank_mask:0xf
  s_waitcnt vmcnt(20)
  v_mfma_f32_16x16x32_bf16 v[28:31], v[220:223], v[92:95], v[28:31]
  buffer_load_dwordx4 v[188:191], v4, s[44:47], s14 offen offset:384 nt
  v_add_f32_dpp v37, v25, v24 quad_perm:[1,1,3,3] row_mask:0xf bank_mask:0xf
  v_add_f32_dpp v39, v27, v26 quad_perm:[1,1,3,3] row_mask:0xf bank_mask:0xf
  v_cvt_pk_bf16_f32 v37, v36, v37
  v_cvt_pk_bf16_f32 v39, v38, v39
  s_waitcnt vmcnt(20)
  v_mfma_f32_16x16x32_bf16 v[32:35], v[224:227], v[80:83], 0
  buffer_load_dwordx4 v[192:195], v4, s[44:47], s14 offen offset:512 nt
  v_lshlrev_b32 v36, 16, v37
  v_lshlrev_b32 v38, 16, v39
  v_and_b32 v37, 0xffff0000, v37
  v_and_b32 v39, 0xffff0000, v39
  s_waitcnt vmcnt(20)
  v_mfma_f32_16x16x32_bf16 v[32:35], v[228:231], v[84:87], v[32:35]
  buffer_load_dwordx4 v[196:199], v4, s[44:47], s14 offen offset:640 nt
  s_mov_b64 exec, s[62:63]
  ds_write_b128 v107, v[36:39] offset:4864
  s_mov_b64 exec, -1
  v_max3_f32 v6, v6, v36, v38
  v_max3_f32 v6, v6, v37, v39
  s_waitcnt vmcnt(20)
  v_mfma_f32_16x16x32_bf16 v[32:35], v[232:235], v[88:91], v[32:35]
  buffer_load_dwordx4 v[200:203], v4, s[44:47], s14 offen offset:768 nt
  s_waitcnt vmcnt(20)
  v_mfma_f32_16x16x32_bf16 v[32:35], v[236:239], v[92:95], v[32:35]
  buffer_load_dwordx4 v[204:207], v4, s[44:47], s14 offen offset:896 nt
  s_or_b32 s14, s14, 0xe10000
  s_add_u32 s14, s14, 8192
  s_and_b32 s14, s14, 0xff1ee000
  s_waitcnt lgkmcnt(1)
  v_add_u32 v107, 512, v107
  s_sub_u32 s11, s11, 1
  s_cmp_eq_u32 s11, 0
  s_cbranch_scc1 L_loop1_done
  v_readfirstlane_b32 s15, v248
  s_nop 3
  s_cmp_eq_u32 s15, 0
  s_cbranch_scc1 L_loop1_0
  s_cmp_eq_u32 s15, 1
  s_cbranch_scc1 L_loop1_1
  s_cmp_eq_u32 s15, 2
  s_cbranch_scc1 L_loop1_2
  s_branch L_loop1_3
L_loop1_2:
  s_waitcnt vmcnt(22)
  v_mfma_f32_16x16x32_bf16 v[20:23], v[112:115], v[80:83], 0
  buffer_load_dwordx4 v[208:211], v4, s[44:47], s14 offen offset:0 nt
  s_waitcnt vmcnt(22)
  v_mfma_f32_16x16x32_bf16 v[20:23], v[116:119], v[84:87], v[20:23]
  buffer_load_dwordx4 v[212:215], v4, s[44:47], s14 offen offset:128 nt
  s_waitcnt vmcnt(22)
  v_mfma_f32_16x16x32_bf16 v[20:23], v[120:123], v[88:91], v[20:23]
  buffer_load_dwordx4 v[216:219], v4, s[44:47], s14 offen offset:256 nt
  v_add_f32_dpp v36, v29, v28 quad_perm:[1,1,3,3] row_mask:0xf bank_mask:0xf
  v_add_f32_dpp v38, v31, v30 quad_perm:[1,1,3,3] row_mask:0xf bank_mask:0xf
  s_waitcnt vmcnt(22)
  v_mfma_f32_16x16x32_bf16 v[20:23], v[124:127], v[92:95], v[20:23]
  buffer_load_dwordx4 v[220:223], v4, s[44:47], s14 offen offset:384 nt
  v_add_f32_dpp v37, v33, v32 quad_perm:[1,1,3,3] row_mask:0xf bank_mask:0xf
  v_add_f32_dpp v39, v35, v34 quad_perm:[1,1,3,3] row_mask:0xf bank_mask:0xf
  v_cvt_pk_bf16_f32 v37, v36, v37
  v_cvt_pk_bf16_f32 v39, v38, v39
  s_waitcnt vmcnt(22)
  v_mfma_f32_16x16x32_bf16 v[24:27], v[128:131], v[80:83], 0
  buffer_load_dwordx4 v[224:227], v4, s[44:47], s14 offen offset:512 nt
  v_lshlrev_b32 v36, 16, v37
  v_lshlrev_b32 v38, 16, v39
  v_and_b32 v37, 0xffff0000, v37
  v_and_b32 v39, 0xffff0000, v39
  s_waitcnt vmcnt(22)
  v_mfma_f32_16x16x32_bf16 v[24:27], v[132:135], v[84:87], v[24:27]
  buffer_load_dwordx4 v[228:231], v4, s[44:47], s14 offen offset:640 nt
  s_mov_b64 exec, s[62:63]
  ds_write_b128 v107, v[36:39] offset:4480
  s_mov_b64 exec, -1
  v_max3_f32 v6, v6, v36, v38
  v_max3_f32 v6, v6, v37, v39
  s_waitcnt vmcnt(22)
  v_mfma_f32_16x16x32_bf16 v[24:27], v[136:139], v[88:91], v[24:27]
  buffer_load_dwordx4 v[232:235], v4, s[44:47], s14 offen offset:768 nt
  s_waitcnt vmcnt(22)
  v_mfma_f32_16x16x32_bf16 v[24:27], v[140:143], v[92:95], v[24:27]
  buffer_load_dwordx4 v[236:239], v4, s[44:47], s14 offen offset:896 nt
  s_or_b32 s14, s14, 0xe10000
  s_add_u32 s14, s14, 8192
  s_and_b32 s14, s14, 0xff1ee000
  s_waitcnt vmcnt(22)
  v_mfma_f32_16x16x32_bf16 v[28:31], v[144:147], v[80:83], 0
  buffer_load_dwordx4 v[112:115], v4, s[44:47], s14 offen offset:0 nt
  s_waitcnt vmcnt(22)
  v_mfma_f32_16x16x32_bf16 v[28:31], v[148:151], v[84:87], v[28:31]
  buffer_load_dwordx4 v[116:119], v4, s[44:47], s14 offen offset:128 nt
  s_waitcnt vmcnt(22)
  v_mfma_f32_16x16x32_bf16 v[28:31], v[152:155], v[88:91], v[28:31]
  buffer_load_dwordx4 v[120:123], v4, s[44:47], s14 offen offset:256 nt
  v_add_f32_dpp v36, v21, v20 quad_perm:[1,1,3,3] row_mask:0xf bank_mask:0xf
  v_add_f32_dpp v38, v23, v22 quad_perm:[1,1,3,3] row_mask:0xf bank_mask:0xf
  s_waitcnt vmcnt(22)
  v_mfma_f32_16x16x32_bf16 v[28:31], v[156:159], v[92:95], v[28:31]
  buffer_load_dwordx4 v[124:127], v4, s[44:47], s14 offen offset:384 nt
  v_add_f32_dpp v37, v25, v24 quad_perm:[1,1,3,3] row_mask:0xf bank_mask:0xf
  v_add_f32_dpp v39, v27, v26 quad_perm:[1,1,3,3] row_mask:0xf bank_mask:0xf
  v_cvt_pk_bf16_f32 v37, v36, v37
  v_cvt_pk_bf16_f32 v39, v38, v39
  s_waitcnt vmcnt(22)
  v_mfma_f32_16x16x32_bf16 v[32:35], v[160:163], v[80:83], 0
  buffer_load_dwordx4 v[128:131], v4, s[44:47], s14 offen offset:512 nt
  v_lshlrev_b32 v36, 16, v37
  v_lshlrev_b32 v38, 16, v39
  v_and_b32 v37, 0xffff0000, v37
  v_and_b32 v39, 0xffff0000, v39
  s_waitcnt vmcnt(22)
  v_mfma_f32_16x16x32_bf16 v[32:35], v[164:167], v[84:87], v[32:35]
  buffer_load_dwordx4 v[132:135], v4, s[44:47], s14 offen offset:640 nt
  s_mov_b64 exec, s[62:63]
  ds_write_b128 v107, v[36:39] offset:4608
  s_mov_b64 exec, -1
  v_max3_f32 v6, v6, v36, v38
  v_max3_f32 v6, v6, v37, v39
  s_waitcnt vmcnt(22)
  v_mfma_f32_16x16x32_bf16 v[32:35], v[168:171], v[88:91], v[32:35]
  buffer_load_dwordx4 v[136:139], v4, s[44:47], s14 offen offset:768 nt
  s_waitcnt vmcnt(22)
  v_mfma_f32_16x16x32_bf16 v[32:35], v[172:175], v[92:95], v[32:35]
  buffer_load_dwordx4 v[140:143], v4, s[44:47], s14 offen offset:896 nt
  s_or_b32 s14, s14, 0xe10000
  s_add_u32 s14, s14, 8192
  s_and_b32 s14, s14, 0xff1ee000
  s_waitcnt vmcnt(22)
  v_mfma_f32_16x16x32_bf16 v[20:23], v[176:179], v[80:83], 0
  buffer_load_dwordx4 v[144:147], v4, s[44:47], s14 offen offset:0 nt
  s_waitcnt vmcnt(22)
  v_mfma_f32_16x16x32_bf16 v[20:23], v[180:183], v[84:87], v[20:23]
  buffer_load_dwordx4 v[148:151], v4, s[44:47], s14 offen offset:128 nt
  s_waitcnt vmcnt(22)
  v_mfma_f32_16x16x32_bf16 v[20:23], v[184:187], v[88:91], v[20:23]
  buffer_load_dwordx4 v[152:155], v4, s[44:47], s14 offen offset:256 nt
  v_add_f32_dpp v36, v29, v28 quad_perm:[1,1,3,3] row_mask:0xf bank_mask:0xf
  v_add_f32_dpp v38, v31, v30 quad_perm:[1,1,3,3] row_mask:0xf bank_mask:0xf
  s_waitcnt vmcnt(22)
  v_mfma_f32_16x16x32_bf16 v[20:23], v[188:191], v[92:95], v[20:23]
  buffer_load_dwordx4 v[156:159], v4, s[44:47], s14 offen offset:384 nt
  v_add_f32_dpp v37, v33, v32 quad_perm:[1,1,3,3] row_mask:0xf bank_mask:0xf
  v_add_f32_dpp v39, v35, v34 quad_perm:[1,1,3,3] row_mask:0xf bank_mask:0xf
  v_cvt_pk_bf16_f32 v37, v36, v37
  v_cvt_pk_bf16_f32 v39, v38, v39
  s_waitcnt vmcnt(22)
  v_mfma_f32_16x16x32_bf16 v[24:27], v[192:195], v[80:83], 0
  buffer_load_dwordx4 v[160:163], v4, s[44:47], s14 offen offset:512 nt
  v_lshlrev_b32 v36, 16, v37
  v_lshlrev_b32 v38, 16, v39
  v_and_b32 v37, 0xffff0000, v37
  v_and_b32 v39, 0xffff0000, v39
  s_waitcnt vmcnt(22)
  v_mfma_f32_16x16x32_bf16 v[24:27], v[196:199], v[84:87], v[24:27]
  buffer_load_dwordx4 v[164:167], v4, s[44:47], s14 offen offset:640 nt
  s_mov_b64 exec, s[62:63]
  ds_write_b128 v107, v[36:39] offset:4736
  s_mov_b64 exec, -1
  v_max3_f32 v6, v6, v36, v38
  v_max3_f32 v6, v6, v37, v39
  s_waitcnt vmcnt(22)
  v_mfma_f32_16x16x32_bf16 v[24:27], v[200:203], v[88:91], v[24:27]
  buffer_load_dwordx4 v[168:171], v4, s[44:47], s14 offen offset:768 nt
  s_waitcnt vmcnt(22)
  v_mfma_f32_16x16x32_bf16 v[24:27], v[204:207], v[92:95], v[24:27]
  buffer_load_dwordx4 v[172:175], v4, s[44:47], s14 offen offset:896 nt
  s_or_b32 s14, s14, 0xe10000
  s_add_u32 s14, s14, 8192
  s_and_b32 s14, s14, 0xff1ee000
  s_waitcnt vmcnt(22)
  v_mfma_f32_16x16x32_bf16 v[28:31], v[208:211], v[80:83], 0
  buffer_load_dwordx4 v[176:179], v4, s[44:47], s14 offen offset:0 nt
  v_add_u32 v243, 1, v243
  ds_write_b32 v15, v243 offset:1032
  ds_read_b32 v248, v15 offset:1036
  s_waitcnt vmcnt(22)
  v_mfma_f32_16x16x32_bf16 v[28:31], v[212:215], v[84:87], v[28:31]
  buffer_load_dwordx4 v[180:183], v4, s[44:47], s14 offen offset:128 nt
  s_waitcnt vmcnt(22)
  v_mfma_f32_16x16x32_bf16 v[28:31], v[216:219], v[88:91], v[28:31]
  buffer_load_dwordx4 v[184:187], v4, s[44:47], s14 offen offset:256 nt
  v_add_f32_dpp v36, v21, v20 quad_perm:[1,1,3,3] row_mask:0xf bank_mask:0xf
  v_add_f32_dpp v38, v23, v22 quad_perm:[1,1,3,3] row_mask:0xf bank_mask:0xf
  s_waitcnt vmcnt(22)
  v_mfma_f32_16x16x32_bf16 v[28:31], v[220:223], v[92:95], v[28:31]
  buffer_load_dwordx4 v[188:191], v4, s[44:47], s14 offen offset:384 nt
  v_add_f32_dpp v37, v25, v24 quad_perm:[1,1,3,3] row_mask:0xf bank_mask:0xf
  v_add_f32_dpp v39, v27, v26 quad_perm:[1,1,3,3] row_mask:0xf bank_mask:0xf
  v_cvt_pk_bf16_f32 v37, v36, v37
  v_cvt_pk_bf16_f32 v39, v38, v39
  s_waitcnt vmcnt(22)
  v_mfma_f32_16x16x32_bf16 v[32:35], v[224:227], v[80:83], 0
  buffer_load_dwordx4 v[192:195], v4, s[44:47], s14 offen offset:512 nt
  v_lshlrev_b32 v36, 16, v37
  v_lshlrev_b32 v38, 16, v39
  v_and_b32 v37, 0xffff0000, v37
  v_and_b32 v39, 0xffff0000, v39
  s_waitcnt vmcnt(22)
  v_mfma_f32_16x16x32_bf16 v[32:35], v[228:231], v[84:87], v[32:35]
  buffer_load_dwordx4 v[196:199], v4, s[44:47], s14 offen offset:640 nt
  s_mov_b64 exec, s[62:63]
  ds_write_b128 v107, v[36:39] offset:4864
  s_mov_b64 exec, -1
  v_max3_f32 v6, v6, v36, v38
  v_max3_f32 v6, v6, v37, v39
  s_waitcnt vmcnt(22)
  v_mfma_f32_16x16x32_bf16 v[32:35], v[232:235], v[88:91], v[32:35]
  buffer_load_dwordx4 v[200:203], v4, s[44:47], s14 offen offset:768 nt
  s_waitcnt vmcnt(22)
  v_mfma_f32_16x16x32_bf16 v[32:35], v[236:239], v[92:95], v[32:35]
  buffer_load_dwordx4 v[204:207], v4, s[44:47], s14 offen offset:896 nt
  s_or_b32 s14, s14, 0xe10000
  s_add_u32 s14, s14, 8192
  s_and_b32 s14, s14, 0xff1ee000
  s_waitcnt lgkmcnt(1)
  v_add_u32 v107, 512, v107
  s_sub_u32 s11, s11, 1
  s_cmp_eq_u32 s11, 0
  s_cbranch_scc1 L_loop1_done
  v_readfirstlane_b32 s15, v248
  s_nop 3
  s_cmp_eq_u32 s15, 0
  s_cbranch_scc1 L_loop1_0
  s_cmp_eq_u32 s15, 1
  s_cbranch_scc1 L_loop1_1
  s_cmp_eq_u32 s15, 2
  s_cbranch_scc1 L_loop1_2
  s_branch L_loop1_3
L_loop1_3:
  s_waitcnt vmcnt(23)
  v_mfma_f32_16x16x32_bf16 v[20:23], v[112:115], v[80:83], 0
  buffer_load_dwordx4 v[208:211], v4, s[44:47], s14 offen offset:0 nt
  s_waitcnt vmcnt(23)
  v_mfma_f32_16x16x32_bf16 v[20:23], v[116:119], v[84:87], v[20:23]
  buffer_load_dwordx4 v[212:215], v4, s[44:47], s14 offen offset:128 nt
  s_waitcnt vmcnt(23)
  v_mfma_f32_16x16x32_bf16 v[20:23], v[120:123], v[88:91], v[20:23]
  buffer_load_dwordx4 v[216:219], v4, s[44:47], s14 offen offset:256 nt
  v_add_f32_dpp v36, v29, v28 quad_perm:[1,1,3,3] row_mask:0xf bank_mask:0xf
  v_add_f32_dpp v38, v31, v30 quad_perm:[1,1,3,3] row_mask:0xf bank_mask:0xf
  s_waitcnt vmcnt(23)
  v_mfma_f32_16x16x32_bf16 v[20:23], v[124:127], v[92:95], v[20:23]
  buffer_load_dwordx4 v[220:223], v4, s[44:47], s14 offen offset:384 nt
  v_add_f32_dpp v37, v33, v32 quad_perm:[1,1,3,3] row_mask:0xf bank_mask:0xf
  v_add_f32_dpp v39, v35, v34 quad_perm:[1,1,3,3] row_mask:0xf bank_mask:0xf
  v_cvt_pk_bf16_f32 v37, v36, v37
  v_cvt_pk_bf16_f32 v39, v38, v39
  s_waitcnt vmcnt(23)
  v_mfma_f32_16x16x32_bf16 v[24:27], v[128:131], v[80:83], 0
  buffer_load_dwordx4 v[224:227], v4, s[44:47], s14 offen offset:512 nt
  v_lshlrev_b32 v36, 16, v37
  v_lshlrev_b32 v38, 16, v39
  v_and_b32 v37, 0xffff0000, v37
  v_and_b32 v39, 0xffff0000, v39
  s_waitcnt vmcnt(23)
  v_mfma_f32_16x16x32_bf16 v[24:27], v[132:135], v[84:87], v[24:27]
  buffer_load_dwordx4 v[228:231], v4, s[44:47], s14 offen offset:640 nt
  s_mov_b64 exec, s[62:63]
  ds_write_b128 v107, v[36:39] offset:4480
  s_mov_b64 exec, -1
  v_max3_f32 v6, v6, v36, v38
  v_max3_f32 v6, v6, v37, v39
  s_waitcnt vmcnt(23)
  v_mfma_f32_16x16x32_bf16 v[24:27], v[136:139], v[88:91], v[24:27]
  buffer_load_dwordx4 v[232:235], v4, s[44:47], s14 offen offset:768 nt
  s_waitcnt vmcnt(23)
  v_mfma_f32_16x16x32_bf16 v[24:27], v[140:143], v[92:95], v[24:27]
  buffer_load_dwordx4 v[236:239], v4, s[44:47], s14 offen offset:896 nt
  s_or_b32 s14, s14, 0xe10000
  s_add_u32 s14, s14, 8192
  s_and_b32 s14, s14, 0xff1ee000
  s_waitcnt vmcnt(23)
  v_mfma_f32_16x16x32_bf16 v[28:31], v[144:147], v[80:83], 0
  buffer_load_dwordx4 v[112:115], v4, s[44:47], s14 offen offset:0 nt
  s_waitcnt vmcnt(23)
  v_mfma_f32_16x16x32_bf16 v[28:31], v[148:151], v[84:87], v[28:31]
  buffer_load_dwordx4 v[116:119], v4, s[44:47], s14 offen offset:128 nt
  s_waitcnt vmcnt(23)
  v_mfma_f32_16x16x32_bf16 v[28:31], v[152:155], v[88:91], v[28:31]
  buffer_load_dwordx4 v[120:123], v4, s[44:47], s14 offen offset:256 nt
  v_add_f32_dpp v36, v21, v20 quad_perm:[1,1,3,3] row_mask:0xf bank_mask:0xf
  v_add_f32_dpp v38, v23, v22 quad_perm:[1,1,3,3] row_mask:0xf bank_mask:0xf
  s_waitcnt vmcnt(23)
  v_mfma_f32_16x16x32_bf16 v[28:31], v[156:159], v[92:95], v[28:31]
  buffer_load_dwordx4 v[124:127], v4, s[44:47], s14 offen offset:384 nt
  v_add_f32_dpp v37, v25, v24 quad_perm:[1,1,3,3] row_mask:0xf bank_mask:0xf
  v_add_f32_dpp v39, v27, v26 quad_perm:[1,1,3,3] row_mask:0xf bank_mask:0xf
  v_cvt_pk_bf16_f32 v37, v36, v37
  v_cvt_pk_bf16_f32 v39, v38, v39
  s_waitcnt vmcnt(23)
  v_mfma_f32_16x16x32_bf16 v[32:35], v[160:163], v[80:83], 0
  buffer_load_dwordx4 v[128:131], v4, s[44:47], s14 offen offset:512 nt
  v_lshlrev_b32 v36, 16, v37
  v_lshlrev_b32 v38, 16, v39
  v_and_b32 v37, 0xffff0000, v37
  v_and_b32 v39, 0xffff0000, v39
  s_waitcnt vmcnt(23)
  v_mfma_f32_16x16x32_bf16 v[32:35], v[164:167], v[84:87], v[32:35]
  buffer_load_dwordx4 v[132:135], v4, s[44:47], s14 offen offset:640 nt
  s_mov_b64 exec, s[62:63]
  ds_write_b128 v107, v[36:39] offset:4608
  s_mov_b64 exec, -1
  v_max3_f32 v6, v6, v36, v38
  v_max3_f32 v6, v6, v37, v39
  s_waitcnt vmcnt(23)
  v_mfma_f32_16x16x32_bf16 v[32:35], v[168:171], v[88:91], v[32:35]
  buffer_load_dwordx4 v[136:139], v4, s[44:47], s14 offen offset:768 nt
  s_waitcnt vmcnt(23)
  v_mfma_f32_16x16x32_bf16 v[32:35], v[172:175], v[92:95], v[32:35]
  buffer_load_dwordx4 v[140:143], v4, s[44:47], s14 offen offset:896 nt
  s_or_b32 s14, s14, 0xe10000
  s_add_u32 s14, s14, 8192
  s_and_b32 s14, s14, 0xff1ee000
  s_waitcnt vmcnt(23)
  v_mfma_f32_16x16x32_bf16 v[20:23], v[176:179], v[80:83], 0
  buffer_load_dwordx4 v[144:147], v4, s[44:47], s14 offen offset:0 nt
  s_waitcnt vmcnt(23)
  v_mfma_f32_16x16x32_bf16 v[20:23], v[180:183], v[84:87], v[20:23]
  buffer_load_dwordx4 v[148:151], v4, s[44:47], s14 offen offset:128 nt
  s_waitcnt vmcnt(23)
  v_mfma_f32_16x16x32_bf16 v[20:23], v[184:187], v[88:91], v[20:23]
  buffer_load_dwordx4 v[152:155], v4, s[44:47], s14 offen offset:256 nt
  v_add_f32_dpp v36, v29, v28 quad_perm:[1,1,3,3] row_mask:0xf bank_mask:0xf
  v_add_f32_dpp v38, v31, v30 quad_perm:[1,1,3,3] row_mask:0xf bank_mask:0xf
  s_waitcnt vmcnt(23)
  v_mfma_f32_16x16x32_bf16 v[20:23], v[188:191], v[92:95], v[20:23]
  buffer_load_dwordx4 v[156:159], v4, s[44:47], s14 offen offset:384 nt
  v_add_f32_dpp v37, v33, v32 quad_perm:[1,1,3,3] row_mask:0xf bank_mask:0xf
  v_add_f32_dpp v39, v35, v34 quad_perm:[1,1,3,3] row_mask:0xf bank_mask:0xf
  v_cvt_pk_bf16_f32 v37, v36, v37
  v_cvt_pk_bf16_f32 v39, v38, v39
  s_waitcnt vmcnt(23)
  v_mfma_f32_16x16x32_bf16 v[24:27], v[192:195], v[80:83], 0
  buffer_load_dwordx4 v[160:163], v4, s[44:47], s14 offen offset:512 nt
  v_lshlrev_b32 v36, 16, v37
  v_lshlrev_b32 v38, 16, v39
  v_and_b32 v37, 0xffff0000, v37
  v_and_b32 v39, 0xffff0000, v39
  s_waitcnt vmcnt(23)
  v_mfma_f32_16x16x32_bf16 v[24:27], v[196:199], v[84:87], v[24:27]
  buffer_load_dwordx4 v[164:167], v4, s[44:47], s14 offen offset:640 nt
  s_mov_b64 exec, s[62:63]
  ds_write_b128 v107, v[36:39] offset:4736
  s_mov_b64 exec, -1
  v_max3_f32 v6, v6, v36, v38
  v_max3_f32 v6, v6, v37, v39
  s_waitcnt vmcnt(23)
  v_mfma_f32_16x16x32_bf16 v[24:27], v[200:203], v[88:91], v[24:27]
  buffer_load_dwordx4 v[168:171], v4, s[44:47], s14 offen offset:768 nt
  s_waitcnt vmcnt(23)
  v_mfma_f32_16x16x32_bf16 v[24:27], v[204:207], v[92:95], v[24:27]
  buffer_load_dwordx4 v[172:175], v4, s[44:47], s14 offen offset:896 nt
  s_or_b32 s14, s14, 0xe10000
  s_add_u32 s14, s14, 8192
  s_and_b32 s14, s14, 0xff1ee000
  s_waitcnt vmcnt(23)
  v_mfma_f32_16x16x32_bf16 v[28:31], v[208:211], v[80:83], 0
  buffer_load_dwordx4 v[176:179], v4, s[44:47], s14 offen offset:0 nt
  v_add_u32 v243, 1, v243
  ds_write_b32 v15, v243 offset:1032
  ds_read_b32 v248, v15 offset:1036
  s_waitcnt vmcnt(23)
  v_mfma_f32_16x16x32_bf16 v[28:31], v[212:215], v[84:87], v[28:31]
  buffer_load_dwordx4 v[180:183], v4, s[44:47], s14 offen offset:128 nt
  s_waitcnt vmcnt(23)
  v_mfma_f32_16x16x32_bf16 v[28:31], v[216:219], v[88:91], v[28:31]
  buffer_load_dwordx4 v[184:187], v4, s[44:47], s14 offen offset:256 nt
  v_add_f32_dpp v36, v21, v20 quad_perm:[1,1,3,3] row_mask:0xf bank_mask:0xf
  v_add_f32_dpp v38, v23, v22 quad_perm:[1,1,3,3] row_mask:0xf bank_mask:0xf
  s_waitcnt vmcnt(23)
  v_mfma_f32_16x16x32_bf16 v[28:31], v[220:223], v[92:95], v[28:31]
  buffer_load_dwordx4 v[188:191], v4, s[44:47], s14 offen offset:384 nt
  v_add_f32_dpp v37, v25, v24 quad_perm:[1,1,3,3] row_mask:0xf bank_mask:0xf
  v_add_f32_dpp v39, v27, v26 quad_perm:[1,1,3,3] row_mask:0xf bank_mask:0xf
  v_cvt_pk_bf16_f32 v37, v36, v37
  v_cvt_pk_bf16_f32 v39, v38, v39
  s_waitcnt vmcnt(23)
  v_mfma_f32_16x16x32_bf16 v[32:35], v[224:227], v[80:83], 0
  buffer_load_dwordx4 v[192:195], v4, s[44:47], s14 offen offset:512 nt
  v_lshlrev_b32 v36, 16, v37
  v_lshlrev_b32 v38, 16, v39
  v_and_b32 v37, 0xffff0000, v37
  v_and_b32 v39, 0xffff0000, v39
  s_waitcnt vmcnt(23)
  v_mfma_f32_16x16x32_bf16 v[32:35], v[228:231], v[84:87], v[32:35]
  buffer_load_dwordx4 v[196:199], v4, s[44:47], s14 offen offset:640 nt
  s_mov_b64 exec, s[62:63]
  ds_write_b128 v107, v[36:39] offset:4864
  s_mov_b64 exec, -1
  v_max3_f32 v6, v6, v36, v38
  v_max3_f32 v6, v6, v37, v39
  s_waitcnt vmcnt(23)
  v_mfma_f32_16x16x32_bf16 v[32:35], v[232:235], v[88:91], v[32:35]
  buffer_load_dwordx4 v[200:203], v4, s[44:47], s14 offen offset:768 nt
  s_waitcnt vmcnt(23)
  v_mfma_f32_16x16x32_bf16 v[32:35], v[236:239], v[92:95], v[32:35]
  buffer_load_dwordx4 v[204:207], v4, s[44:47], s14 offen offset:896 nt
  s_or_b32 s14, s14, 0xe10000
  s_add_u32 s14, s14, 8192
  s_and_b32 s14, s14, 0xff1ee000
  s_waitcnt lgkmcnt(1)
  v_add_u32 v107, 512, v107
  s_sub_u32 s11, s11, 1
  s_cmp_eq_u32 s11, 0
  s_cbranch_scc1 L_loop1_done
  v_readfirstlane_b32 s15, v248
  s_nop 3
  s_cmp_eq_u32 s15, 0
  s_cbranch_scc1 L_loop1_0
  s_cmp_eq_u32 s15, 1
  s_cbranch_scc1 L_loop1_1
  s_cmp_eq_u32 s15, 2
  s_cbranch_scc1 L_loop1_2
  s_branch L_loop1_3
L_loop1_done:
  s_waitcnt vmcnt(20)
  v_mfma_f32_16x16x32_bf16 v[20:23], v[112:115], v[80:83], 0
  buffer_load_dwordx4 v[208:211], v4, s[44:47], s14 offen offset:0 nt
  s_waitcnt vmcnt(20)
  v_mfma_f32_16x16x32_bf16 v[20:23], v[116:119], v[84:87], v[20:23]
  buffer_load_dwordx4 v[212:215], v4, s[44:47], s14 offen offset:128 nt
  s_waitcnt vmcnt(20)
  v_mfma_f32_16x16x32_bf16 v[20:23], v[120:123], v[88:91], v[20:23]
  buffer_load_dwordx4 v[216:219], v4, s[44:47], s14 offen offset:256 nt
  v_add_f32_dpp v36, v29, v28 quad_perm:[1,1,3,3] row_mask:0xf bank_mask:0xf
  v_add_f32_dpp v38, v31, v30 quad_perm:[1,1,3,3] row_mask:0xf bank_mask:0xf
  s_waitcnt vmcnt(20)
  v_mfma_f32_16x16x32_bf16 v[20:23], v[124:127], v[92:95], v[20:23]
  buffer_load_dwordx4 v[220:223], v4, s[44:47], s14 offen offset:384 nt
  v_add_f32_dpp v37, v33, v32 quad_perm:[1,1,3,3] row_mask:0xf bank_mask:0xf
  v_add_f32_dpp v39, v35, v34 quad_perm:[1,1,3,3] row_mask:0xf bank_mask:0xf
  v_cvt_pk_bf16_f32 v37, v36, v37
  v_cvt_pk_bf16_f32 v39, v38, v39
  s_waitcnt vmcnt(20)
  v_mfma_f32_16x16x32_bf16 v[24:27], v[128:131], v[80:83], 0
  buffer_load_dwordx4 v[224:227], v4, s[44:47], s14 offen offset:512 nt
  v_lshlrev_b32 v36, 16, v37
  v_lshlrev_b32 v38, 16, v39
  v_and_b32 v37, 0xffff0000, v37
  v_and_b32 v39, 0xffff0000, v39
  s_waitcnt vmcnt(20)
  v_mfma_f32_16x16x32_bf16 v[24:27], v[132:135], v[84:87], v[24:27]
  buffer_load_dwordx4 v[228:231], v4, s[44:47], s14 offen offset:640 nt
  s_mov_b64 exec, s[62:63]
  ds_write_b128 v107, v[36:39] offset:4480
  s_mov_b64 exec, -1
  v_max3_f32 v6, v6, v36, v38
  v_max3_f32 v6, v6, v37, v39
  s_waitcnt vmcnt(20)
  v_mfma_f32_16x16x32_bf16 v[24:27], v[136:139], v[88:91], v[24:27]
  buffer_load_dwordx4 v[232:235], v4, s[44:47], s14 offen offset:768 nt
  s_waitcnt vmcnt(20)
  v_mfma_f32_16x16x32_bf16 v[24:27], v[140:143], v[92:95], v[24:27]
  buffer_load_dwordx4 v[236:239], v4, s[44:47], s14 offen offset:896 nt
  s_or_b32 s14, s14, 0xe10000
  s_add_u32 s14, s14, 8192
  s_and_b32 s14, s14, 0xff1ee000
  s_waitcnt vmcnt(20)
  v_mfma_f32_16x16x32_bf16 v[28:31], v[144:147], v[80:83], 0
  buffer_load_dwordx4 v[112:115], v5, s[48:51], s75 offen offset:0 nt
  s_waitcnt vmcnt(20)
  v_mfma_f32_16x16x32_bf16 v[28:31], v[148:151], v[84:87], v[28:31]
  buffer_load_dwordx4 v[116:119], v5, s[48:51], s75 offen offset:256 nt
  s_waitcnt vmcnt(20)
  v_mfma_f32_16x16x32_bf16 v[28:31], v[152:155], v[88:91], v[28:31]
  buffer_load_dwordx4 v[120:123], v5, s[48:51], s75 offen offset:512 nt
  v_add_f32_dpp v36, v21, v20 quad_perm:[1,1,3,3] row_mask:0xf bank_mask:0xf
  v_add_f32_dpp v38, v23, v22 quad_perm:[1,1,3,3] row_mask:0xf bank_mask:0xf
  s_waitcnt vmcnt(20)
  v_mfma_f32_16x16x32_bf16 v[28:31], v[156:159], v[92:95], v[28:31]
  buffer_load_dwordx4 v[124:127], v5, s[48:51], s75 offen offset:768 nt
  v_add_f32_dpp v37, v25, v24 quad_perm:[1,1,3,3] row_mask:0xf bank_mask:0xf
  v_add_f32_dpp v39, v27, v26 quad_perm:[1,1,3,3] row_mask:0xf bank_mask:0xf
  v_cvt_pk_bf16_f32 v37, v36, v37
  v_cvt_pk_bf16_f32 v39, v38, v39
  s_waitcnt vmcnt(20)
  v_mfma_f32_16x16x32_bf16 v[32:35], v[160:163], v[80:83], 0
  buffer_load_dwordx4 v[128:131], v5, s[48:51], s75 offen offset:1024 nt
  v_lshlrev_b32 v36, 16, v37
  v_lshlrev_b32 v38, 16, v39
  v_and_b32 v37, 0xffff0000, v37
  v_and_b32 v39, 0xffff0000, v39
  s_waitcnt vmcnt(20)
  v_mfma_f32_16x16x32_bf16 v[32:35], v[164:167], v[84:87], v[32:35]
  buffer_load_dwordx4 v[132:135], v5, s[48:51], s75 offen offset:1280 nt
  s_mov_b64 exec, s[62:63]
  ds_write_b128 v107, v[36:39] offset:4608
  s_mov_b64 exec, -1
  v_max3_f32 v6, v6, v36, v38
  v_max3_f32 v6, v6, v37, v39
  s_waitcnt vmcnt(20)
  v_mfma_f32_16x16x32_bf16 v[32:35], v[168:171], v[88:91], v[32:35]
  buffer_load_dwordx4 v[136:139], v5, s[48:51], s75 offen offset:1536 nt
  s_waitcnt vmcnt(20)
  v_mfma_f32_16x16x32_bf16 v[32:35], v[172:175], v[92:95], v[32:35]
  buffer_load_dwordx4 v[140:143], v5, s[48:51], s75 offen offset:1792 nt
  s_or_b32 s75, s75, 0xe10000
  s_add_u32 s75, s75, 8192
  s_and_b32 s75, s75, 0xff1ee000
  s_waitcnt vmcnt(20)
  v_mfma_f32_16x16x32_bf16 v[20:23], v[176:179], v[80:83], 0
  buffer_load_dwordx4 v[144:147], v5, s[48:51], s75 offen offset:0 nt
  s_waitcnt vmcnt(20)
  v_mfma_f32_16x16x32_bf16 v[20:23], v[180:183], v[84:87], v[20:23]
  buffer_load_dwordx4 v[148:151], v5, s[48:51], s75 offen offset:256 nt
  s_waitcnt vmcnt(20)
  v_mfma_f32_16x16x32_bf16 v[20:23], v[184:187], v[88:91], v[20:23]
  buffer_load_dwordx4 v[152:155], v5, s[48:51], s75 offen offset:512 nt
  v_add_f32_dpp v36, v29, v28 quad_perm:[1,1,3,3] row_mask:0xf bank_mask:0xf
  v_add_f32_dpp v38, v31, v30 quad_perm:[1,1,3,3] row_mask:0xf bank_mask:0xf
  s_waitcnt vmcnt(20)
  v_mfma_f32_16x16x32_bf16 v[20:23], v[188:191], v[92:95], v[20:23]
  buffer_load_dwordx4 v[156:159], v5, s[48:51], s75 offen offset:768 nt
  v_add_f32_dpp v37, v33, v32 quad_perm:[1,1,3,3] row_mask:0xf bank_mask:0xf
  v_add_f32_dpp v39, v35, v34 quad_perm:[1,1,3,3] row_mask:0xf bank_mask:0xf
  v_cvt_pk_bf16_f32 v37, v36, v37
  v_cvt_pk_bf16_f32 v39, v38, v39
  s_waitcnt vmcnt(20)
  v_mfma_f32_16x16x32_bf16 v[24:27], v[192:195], v[80:83], 0
  buffer_load_dwordx4 v[160:163], v5, s[48:51], s75 offen offset:1024 nt
  v_lshlrev_b32 v36, 16, v37
  v_lshlrev_b32 v38, 16, v39
  v_and_b32 v37, 0xffff0000, v37
  v_and_b32 v39, 0xffff0000, v39
  s_waitcnt vmcnt(20)
  v_mfma_f32_16x16x32_bf16 v[24:27], v[196:199], v[84:87], v[24:27]
  buffer_load_dwordx4 v[164:167], v5, s[48:51], s75 offen offset:1280 nt
  s_mov_b64 exec, s[62:63]
  ds_write_b128 v107, v[36:39] offset:4736
  s_mov_b64 exec, -1
  v_max3_f32 v6, v6, v36, v38
  v_max3_f32 v6, v6, v37, v39
  s_waitcnt vmcnt(20)
  v_mfma_f32_16x16x32_bf16 v[24:27], v[200:203], v[88:91], v[24:27]
  buffer_load_dwordx4 v[168:171], v5, s[48:51], s75 offen offset:1536 nt
  s_waitcnt vmcnt(20)
  v_mfma_f32_16x16x32_bf16 v[24:27], v[204:207], v[92:95], v[24:27]
  buffer_load_dwordx4 v[172:175], v5, s[48:51], s75 offen offset:1792 nt
  s_or_b32 s75, s75, 0xe10000
  s_add_u32 s75, s75, 8192
  s_and_b32 s75, s75, 0xff1ee000
  s_waitcnt vmcnt(20)
  v_mfma_f32_16x16x32_bf16 v[28:31], v[208:211], v[80:83], 0
  buffer_load_dwordx4 v[176:179], v5, s[48:51], s75 offen offset:0 nt
  s_waitcnt vmcnt(20)
  v_mfma_f32_16x16x32_bf16 v[28:31], v[212:215], v[84:87], v[28:31]
  buffer_load_dwordx4 v[180:183], v5, s[48:51], s75 offen offset:256 nt
  s_waitcnt vmcnt(20)
  v_mfma_f32_16x16x32_bf16 v[28:31], v[216:219], v[88:91], v[28:31]
  buffer_load_dwordx4 v[184:187], v5, s[48:51], s75 offen offset:512 nt
  v_add_f32_dpp v36, v21, v20 quad_perm:[1,1,3,3] row_mask:0xf bank_mask:0xf
  v_add_f32_dpp v38, v23, v22 quad_perm:[1,1,3,3] row_mask:0xf bank_mask:0xf
  s_waitcnt vmcnt(20)
  v_mfma_f32_16x16x32_bf16 v[28:31], v[220:223], v[92:95], v[28:31]
  buffer_load_dwordx4 v[188:191], v5, s[48:51], s75 offen offset:768 nt
  v_add_f32_dpp v37, v25, v24 quad_perm:[1,1,3,3] row_mask:0xf bank_mask:0xf
  v_add_f32_dpp v39, v27, v26 quad_perm:[1,1,3,3] row_mask:0xf bank_mask:0xf
  v_cvt_pk_bf16_f32 v37, v36, v37
  v_cvt_pk_bf16_f32 v39, v38, v39
  s_waitcnt vmcnt(20)
  v_mfma_f32_16x16x32_bf16 v[32:35], v[224:227], v[80:83], 0
  buffer_load_dwordx4 v[192:195], v5, s[48:51], s75 offen offset:1024 nt
  v_lshlrev_b32 v36, 16, v37
  v_lshlrev_b32 v38, 16, v39
  v_and_b32 v37, 0xffff0000, v37
  v_and_b32 v39, 0xffff0000, v39
  s_waitcnt vmcnt(20)
  v_mfma_f32_16x16x32_bf16 v[32:35], v[228:231], v[84:87], v[32:35]
  buffer_load_dwordx4 v[196:199], v5, s[48:51], s75 offen offset:1280 nt
  s_mov_b64 exec, s[62:63]
  ds_write_b128 v107, v[36:39] offset:4864
  s_mov_b64 exec, -1
  v_max3_f32 v6, v6, v36, v38
  v_max3_f32 v6, v6, v37, v39
  s_waitcnt vmcnt(20)
  v_mfma_f32_16x16x32_bf16 v[32:35], v[232:235], v[88:91], v[32:35]
  buffer_load_dwordx4 v[200:203], v5, s[48:51], s75 offen offset:1536 nt
  s_waitcnt vmcnt(20)
  v_mfma_f32_16x16x32_bf16 v[32:35], v[236:239], v[92:95], v[32:35]
  buffer_load_dwordx4 v[204:207], v5, s[48:51], s75 offen offset:1792 nt
  s_or_b32 s75, s75, 0xe10000
  s_add_u32 s75, s75, 8192
  s_and_b32 s75, s75, 0xff1ee000
  s_waitcnt lgkmcnt(0)
  s_waitcnt vmcnt(20)
  buffer_load_dwordx4 v[208:211], v5, s[48:51], s75 offen offset:0 nt
  s_nop 1
  s_waitcnt vmcnt(20)
  buffer_load_dwordx4 v[212:215], v5, s[48:51], s75 offen offset:256 nt
  v_add_f32_dpp v36, v29, v28 quad_perm:[1,1,3,3] row_mask:0xf bank_mask:0xf
  v_add_f32_dpp v38, v31, v30 quad_perm:[1,1,3,3] row_mask:0xf bank_mask:0xf
  v_add_f32_dpp v37, v33, v32 quad_perm:[1,1,3,3] row_mask:0xf bank_mask:0xf
  v_add_f32_dpp v39, v35, v34 quad_perm:[1,1,3,3] row_mask:0xf bank_mask:0xf
  v_cvt_pk_bf16_f32 v37, v36, v37
  v_cvt_pk_bf16_f32 v39, v38, v39
  v_lshlrev_b32 v36, 16, v37
  v_lshlrev_b32 v38, 16, v39
  v_and_b32 v37, 0xffff0000, v37
  v_and_b32 v39, 0xffff0000, v39
  s_mov_b64 exec, s[62:63]
  ds_write_b128 v107, v[36:39] offset:4992
  s_mov_b64 exec, -1
  v_max3_f32 v6, v6, v36, v38
  v_max3_f32 v6, v6, v37, v39
  v_subrev_u32 v107, 14848, v107
  ds_read_b128 v[20:23], v107 offset:4608
  ds_read_b128 v[24:27], v107 offset:4736
  s_waitcnt vmcnt(20)
  buffer_load_dwordx4 v[216:219], v5, s[48:51], s75 offen offset:512 nt
  v_mov_b32 v10, v6
  s_nop 1
  v_permlane32_swap_b32 v6, v10
  v_max_f32 v6, v6, v10
  v_mov_b32 v10, v6
  s_nop 1
  v_permlane16_swap_b32 v6, v10
  v_max_f32 v6, v6, v10
  s_waitcnt vmcnt(20)
  buffer_load_dwordx4 v[220:223], v5, s[48:51], s75 offen offset:768 nt
  v_readlane_b32 s62, v6, 0
  v_readlane_b32 s63, v6, 8
  s_mov_b32 vcc_lo, 0xff00ff00
  s_mov_b32 vcc_hi, 0xff00ff00
  v_mov_b32 v108, s62
  v_mov_b32 v109, s63
  v_cndmask_b32 v6, v108, v109, vcc
  v_mul_f32 v7, s10, v6
  v_sub_f32 v7, 0, v7
  s_waitcnt lgkmcnt(1)
  ds_write_b64 v15, v[108:109] offset:1056
  s_waitcnt vmcnt(20)
  buffer_load_dwordx4 v[224:227], v5, s[48:51], s75 offen offset:1024 nt
  v_fma_f32 v28, v20, s10, v7
  v_fma_f32 v29, v21, s10, v7
  v_fma_f32 v30, v22, s10, v7
  v_fma_f32 v31, v23, s10, v7
  v_exp_f32 v28, v28
  v_exp_f32 v29, v29
  v_exp_f32 v30, v30
  v_exp_f32 v31, v31
  s_waitcnt vmcnt(20)
  buffer_load_dwordx4 v[228:231], v5, s[48:51], s75 offen offset:1280 nt
  v_cvt_pk_bf16_f32 v32, v28, v28
  v_cvt_pk_bf16_f32 v33, v29, v29
  v_cvt_pk_bf16_f32 v34, v30, v30
  v_cvt_pk_bf16_f32 v35, v31, v31
  v_and_b32 v48, v32, v16
  v_and_b32 v49, v32, v17
  v_and_b32 v50, v32, v18
  v_and_b32 v51, v32, v19
  s_waitcnt vmcnt(20)
  buffer_load_dwordx4 v[232:235], v5, s[48:51], s75 offen offset:1536 nt
  v_and_b32 v52, v33, v16
  v_and_b32 v53, v33, v17
  v_and_b32 v54, v33, v18
  v_and_b32 v55, v33, v19
  v_and_b32 v56, v34, v16
  v_and_b32 v57, v34, v17
  v_and_b32 v58, v34, v18
  v_and_b32 v59, v34, v19
  s_waitcnt vmcnt(20)
  buffer_load_dwordx4 v[236:239], v5, s[48:51], s75 offen offset:1792 nt
  v_and_b32 v60, v35, v16
  v_and_b32 v61, v35, v17
  v_and_b32 v62, v35, v18
  v_and_b32 v63, v35, v19
  s_or_b32 s75, s75, 0xe10000
  s_add_u32 s75, s75, 8192
  s_and_b32 s75, s75, 0xff1ee000
  s_mov_b32 s11, 31
  s_branch L_loop2_1
L_loop2_0:
  s_waitcnt vmcnt(18) lgkmcnt(0)
  v_mfma_f32_16x16x32_bf16 v[40:43], v[48:51], v[112:115], v[40:43]
  buffer_load_dwordx4 v[112:115], v5, s[48:51], s75 offen offset:0 nt
  ds_read_b128 v[20:23], v107 offset:4864
  v_fma_f32 v28, v24, s10, v7
  v_fma_f32 v29, v25, s10, v7
  v_fma_f32 v30, v26, s10, v7
  v_fma_f32 v31, v27, s10, v7
  s_waitcnt vmcnt(18)
  v_mfma_f32_16x16x32_bf16 v[44:47], v[48:51], v[116:119], v[44:47]
  buffer_load_dwordx4 v[116:119], v5, s[48:51], s75 offen offset:256 nt
  v_exp_f32 v28, v28
  v_exp_f32 v29, v29
  v_exp_f32 v30, v30
  v_exp_f32 v31, v31
  s_waitcnt vmcnt(18)
  v_mfma_f32_16x16x32_bf16 v[40:43], v[52:55], v[120:123], v[40:43]
  buffer_load_dwordx4 v[120:123], v5, s[48:51], s75 offen offset:512 nt
  v_cvt_pk_bf16_f32 v32, v28, v28
  v_cvt_pk_bf16_f32 v33, v29, v29
  v_cvt_pk_bf16_f32 v34, v30, v30
  v_cvt_pk_bf16_f32 v35, v31, v31
  s_waitcnt vmcnt(18)
  v_mfma_f32_16x16x32_bf16 v[44:47], v[52:55], v[124:127], v[44:47]
  buffer_load_dwordx4 v[124:127], v5, s[48:51], s75 offen offset:768 nt
  v_and_b32 v64, v32, v16
  v_and_b32 v65, v32, v17
  v_and_b32 v66, v32, v18
  v_and_b32 v67, v32, v19
  s_waitcnt vmcnt(18)
  v_mfma_f32_16x16x32_bf16 v[40:43], v[56:59], v[128:131], v[40:43]
  buffer_load_dwordx4 v[128:131], v5, s[48:51], s75 offen offset:1024 nt
  v_and_b32 v68, v33, v16
  v_and_b32 v69, v33, v17
  v_and_b32 v70, v33, v18
  v_and_b32 v71, v33, v19
  s_waitcnt vmcnt(18)
  v_mfma_f32_16x16x32_bf16 v[44:47], v[56:59], v[132:135], v[44:47]
  buffer_load_dwordx4 v[132:135], v5, s[48:51], s75 offen offset:1280 nt
  v_and_b32 v72, v34, v16
  v_and_b32 v73, v34, v17
  v_and_b32 v74, v34, v18
  v_and_b32 v75, v34, v19
  s_waitcnt vmcnt(18)
  v_mfma_f32_16x16x32_bf16 v[40:43], v[60:63], v[136:139], v[40:43]
  buffer_load_dwordx4 v[136:139], v5, s[48:51], s75 offen offset:1536 nt
  v_and_b32 v76, v35, v16
  v_and_b32 v77, v35, v17
  v_and_b32 v78, v35, v18
  v_and_b32 v79, v35, v19
  s_waitcnt vmcnt(18)
  v_mfma_f32_16x16x32_bf16 v[44:47], v[60:63], v[140:143], v[44:47]
  buffer_load_dwordx4 v[140:143], v5, s[48:51], s75 offen offset:1792 nt
  s_or_b32 s75, s75, 0xe10000
  s_add_u32 s75, s75, 8192
  s_and_b32 s75, s75, 0xff1ee000
  s_waitcnt vmcnt(18) lgkmcnt(0)
  v_mfma_f32_16x16x32_bf16 v[40:43], v[64:67], v[144:147], v[40:43]
  buffer_load_dwordx4 v[144:147], v5, s[48:51], s75 offen offset:0 nt
  ds_read_b128 v[24:27], v107 offset:4992
  v_fma_f32 v28, v20, s10, v7
  v_fma_f32 v29, v21, s10, v7
  v_fma_f32 v30, v22, s10, v7
  v_fma_f32 v31, v23, s10, v7
  s_waitcnt vmcnt(18)
  v_mfma_f32_16x16x32_bf16 v[44:47], v[64:67], v[148:151], v[44:47]
  buffer_load_dwordx4 v[148:151], v5, s[48:51], s75 offen offset:256 nt
  v_exp_f32 v28, v28
  v_exp_f32 v29, v29
  v_exp_f32 v30, v30
  v_exp_f32 v31, v31
  s_waitcnt vmcnt(18)
  v_mfma_f32_16x16x32_bf16 v[40:43], v[68:71], v[152:155], v[40:43]
  buffer_load_dwordx4 v[152:155], v5, s[48:51], s75 offen offset:512 nt
  v_cvt_pk_bf16_f32 v32, v28, v28
  v_cvt_pk_bf16_f32 v33, v29, v29
  v_cvt_pk_bf16_f32 v34, v30, v30
  v_cvt_pk_bf16_f32 v35, v31, v31
  s_waitcnt vmcnt(18)
  v_mfma_f32_16x16x32_bf16 v[44:47], v[68:71], v[156:159], v[44:47]
  buffer_load_dwordx4 v[156:159], v5, s[48:51], s75 offen offset:768 nt
  v_and_b32 v48, v32, v16
  v_and_b32 v49, v32, v17
  v_and_b32 v50, v32, v18
  v_and_b32 v51, v32, v19
  s_waitcnt vmcnt(18)
  v_mfma_f32_16x16x32_bf16 v[40:43], v[72:75], v[160:163], v[40:43]
  buffer_load_dwordx4 v[160:163], v5, s[48:51], s75 offen offset:1024 nt
  v_and_b32 v52, v33, v16
  v_and_b32 v53, v33, v17
  v_and_b32 v54, v33, v18
  v_and_b32 v55, v33, v19
  s_waitcnt vmcnt(18)
  v_mfma_f32_16x16x32_bf16 v[44:47], v[72:75], v[164:167], v[44:47]
  buffer_load_dwordx4 v[164:167], v5, s[48:51], s75 offen offset:1280 nt
  v_and_b32 v56, v34, v16
  v_and_b32 v57, v34, v17
  v_and_b32 v58, v34, v18
  v_and_b32 v59, v34, v19
  s_waitcnt vmcnt(18)
  v_mfma_f32_16x16x32_bf16 v[40:43], v[76:79], v[168:171], v[40:43]
  buffer_load_dwordx4 v[168:171], v5, s[48:51], s75 offen offset:1536 nt
  v_and_b32 v60, v35, v16
  v_and_b32 v61, v35, v17
  v_and_b32 v62, v35, v18
  v_and_b32 v63, v35, v19
  s_waitcnt vmcnt(18)
  v_mfma_f32_16x16x32_bf16 v[44:47], v[76:79], v[172:175], v[44:47]
  buffer_load_dwordx4 v[172:175], v5, s[48:51], s75 offen offset:1792 nt
  s_or_b32 s75, s75, 0xe10000
  s_add_u32 s75, s75, 8192
  s_and_b32 s75, s75, 0xff1ee000
  s_waitcnt vmcnt(18) lgkmcnt(0)
  v_mfma_f32_16x16x32_bf16 v[40:43], v[48:51], v[176:179], v[40:43]
  buffer_load_dwordx4 v[176:179], v5, s[48:51], s75 offen offset:0 nt
  ds_read_b128 v[20:23], v107 offset:5120
  v_fma_f32 v28, v24, s10, v7
  v_fma_f32 v29, v25, s10, v7
  v_fma_f32 v30, v26, s10, v7
  v_fma_f32 v31, v27, s10, v7
  s_waitcnt vmcnt(18)
  v_mfma_f32_16x16x32_bf16 v[44:47], v[48:51], v[180:183], v[44:47]
  buffer_load_dwordx4 v[180:183], v5, s[48:51], s75 offen offset:256 nt
  v_exp_f32 v28, v28
  v_exp_f32 v29, v29
  v_exp_f32 v30, v30
  v_exp_f32 v31, v31
  s_waitcnt vmcnt(18)
  v_mfma_f32_16x16x32_bf16 v[40:43], v[52:55], v[184:187], v[40:43]
  buffer_load_dwordx4 v[184:187], v5, s[48:51], s75 offen offset:512 nt
  v_cvt_pk_bf16_f32 v32, v28, v28
  v_cvt_pk_bf16_f32 v33, v29, v29
  v_cvt_pk_bf16_f32 v34, v30, v30
  v_cvt_pk_bf16_f32 v35, v31, v31
  s_waitcnt vmcnt(18)
  v_mfma_f32_16x16x32_bf16 v[44:47], v[52:55], v[188:191], v[44:47]
  buffer_load_dwordx4 v[188:191], v5, s[48:51], s75 offen offset:768 nt
  v_and_b32 v64, v32, v16
  v_and_b32 v65, v32, v17
  v_and_b32 v66, v32, v18
  v_and_b32 v67, v32, v19
  s_waitcnt vmcnt(18)
  v_mfma_f32_16x16x32_bf16 v[40:43], v[56:59], v[192:195], v[40:43]
  buffer_load_dwordx4 v[192:195], v5, s[48:51], s75 offen offset:1024 nt
  v_and_b32 v68, v33, v16
  v_and_b32 v69, v33, v17
  v_and_b32 v70, v33, v18
  v_and_b32 v71, v33, v19
  v_add_u32 v243, 1, v243
  ds_write_b32 v15, v243 offset:1032
  ds_read_b32 v248, v15 offset:1036
  s_waitcnt vmcnt(18)
  v_mfma_f32_16x16x32_bf16 v[44:47], v[56:59], v[196:199], v[44:47]
  buffer_load_dwordx4 v[196:199], v5, s[48:51], s75 offen offset:1280 nt
  v_and_b32 v72, v34, v16
  v_and_b32 v73, v34, v17
  v_and_b32 v74, v34, v18
  v_and_b32 v75, v34, v19
  s_waitcnt vmcnt(18)
  v_mfma_f32_16x16x32_bf16 v[40:43], v[60:63], v[200:203], v[40:43]
  buffer_load_dwordx4 v[200:203], v5, s[48:51], s75 offen offset:1536 nt
  v_and_b32 v76, v35, v16
  v_and_b32 v77, v35, v17
  v_and_b32 v78, v35, v18
  v_and_b32 v79, v35, v19
  s_waitcnt vmcnt(18)
  v_mfma_f32_16x16x32_bf16 v[44:47], v[60:63], v[204:207], v[44:47]
  buffer_load_dwordx4 v[204:207], v5, s[48:51], s75 offen offset:1792 nt
  s_or_b32 s75, s75, 0xe10000
  s_add_u32 s75, s75, 8192
  s_and_b32 s75, s75, 0xff1ee000
  s_waitcnt vmcnt(18) lgkmcnt(0)
  v_mfma_f32_16x16x32_bf16 v[40:43], v[64:67], v[208:211], v[40:43]
  buffer_load_dwordx4 v[208:211], v5, s[48:51], s75 offen offset:0 nt
  ds_read_b128 v[24:27], v107 offset:5248
  v_fma_f32 v28, v20, s10, v7
  v_fma_f32 v29, v21, s10, v7
  v_fma_f32 v30, v22, s10, v7
  v_fma_f32 v31, v23, s10, v7
  s_waitcnt vmcnt(18)
  v_mfma_f32_16x16x32_bf16 v[44:47], v[64:67], v[212:215], v[44:47]
  buffer_load_dwordx4 v[212:215], v5, s[48:51], s75 offen offset:256 nt
  v_exp_f32 v28, v28
  v_exp_f32 v29, v29
  v_exp_f32 v30, v30
  v_exp_f32 v31, v31
  s_waitcnt vmcnt(18)
  v_mfma_f32_16x16x32_bf16 v[40:43], v[68:71], v[216:219], v[40:43]
  buffer_load_dwordx4 v[216:219], v5, s[48:51], s75 offen offset:512 nt
  v_cvt_pk_bf16_f32 v32, v28, v28
  v_cvt_pk_bf16_f32 v33, v29, v29
  v_cvt_pk_bf16_f32 v34, v30, v30
  v_cvt_pk_bf16_f32 v35, v31, v31
  s_waitcnt vmcnt(18)
  v_mfma_f32_16x16x32_bf16 v[44:47], v[68:71], v[220:223], v[44:47]
  buffer_load_dwordx4 v[220:223], v5, s[48:51], s75 offen offset:768 nt
  v_and_b32 v48, v32, v16
  v_and_b32 v49, v32, v17
  v_and_b32 v50, v32, v18
  v_and_b32 v51, v32, v19
  s_waitcnt vmcnt(18)
  v_mfma_f32_16x16x32_bf16 v[40:43], v[72:75], v[224:227], v[40:43]
  buffer_load_dwordx4 v[224:227], v5, s[48:51], s75 offen offset:1024 nt
  v_and_b32 v52, v33, v16
  v_and_b32 v53, v33, v17
  v_and_b32 v54, v33, v18
  v_and_b32 v55, v33, v19
  s_waitcnt vmcnt(18)
  v_mfma_f32_16x16x32_bf16 v[44:47], v[72:75], v[228:231], v[44:47]
  buffer_load_dwordx4 v[228:231], v5, s[48:51], s75 offen offset:1280 nt
  v_and_b32 v56, v34, v16
  v_and_b32 v57, v34, v17
  v_and_b32 v58, v34, v18
  v_and_b32 v59, v34, v19
  s_waitcnt vmcnt(18)
  v_mfma_f32_16x16x32_bf16 v[40:43], v[76:79], v[232:235], v[40:43]
  buffer_load_dwordx4 v[232:235], v5, s[48:51], s75 offen offset:1536 nt
  v_and_b32 v60, v35, v16
  v_and_b32 v61, v35, v17
  v_and_b32 v62, v35, v18
  v_and_b32 v63, v35, v19
  s_waitcnt vmcnt(18)
  v_mfma_f32_16x16x32_bf16 v[44:47], v[76:79], v[236:239], v[44:47]
  buffer_load_dwordx4 v[236:239], v5, s[48:51], s75 offen offset:1792 nt
  s_or_b32 s75, s75, 0xe10000
  s_add_u32 s75, s75, 8192
  s_and_b32 s75, s75, 0xff1ee000
  v_add_u32 v107, 512, v107
  s_sub_u32 s11, s11, 1
  s_cmp_eq_u32 s11, 0
  s_cbranch_scc1 L_loop2_done
  v_readfirstlane_b32 s15, v248
  s_nop 3
  s_cmp_eq_u32 s15, 0
  s_cbranch_scc1 L_loop2_0
  s_cmp_eq_u32 s15, 1
  s_cbranch_scc1 L_loop2_1
  s_cmp_eq_u32 s15, 2
  s_cbranch_scc1 L_loop2_2
  s_branch L_loop2_3
L_loop2_1:
  s_waitcnt vmcnt(20) lgkmcnt(0)
  v_mfma_f32_16x16x32_bf16 v[40:43], v[48:51], v[112:115], v[40:43]
  buffer_load_dwordx4 v[112:115], v5, s[48:51], s75 offen offset:0 nt
  ds_read_b128 v[20:23], v107 offset:4864
  v_fma_f32 v28, v24, s10, v7
  v_fma_f32 v29, v25, s10, v7
  v_fma_f32 v30, v26, s10, v7
  v_fma_f32 v31, v27, s10, v7
  s_waitcnt vmcnt(20)
  v_mfma_f32_16x16x32_bf16 v[44:47], v[48:51], v[116:119], v[44:47]
  buffer_load_dwordx4 v[116:119], v5, s[48:51], s75 offen offset:256 nt
  v_exp_f32 v28, v28
  v_exp_f32 v29, v29
  v_exp_f32 v30, v30
  v_exp_f32 v31, v31
  s_waitcnt vmcnt(20)
  v_mfma_f32_16x16x32_bf16 v[40:43], v[52:55], v[120:123], v[40:43]
  buffer_load_dwordx4 v[120:123], v5, s[48:51], s75 offen offset:512 nt
  v_cvt_pk_bf16_f32 v32, v28, v28
  v_cvt_pk_bf16_f32 v33, v29, v29
  v_cvt_pk_bf16_f32 v34, v30, v30
  v_cvt_pk_bf16_f32 v35, v31, v31
  s_waitcnt vmcnt(20)
  v_mfma_f32_16x16x32_bf16 v[44:47], v[52:55], v[124:127], v[44:47]
  buffer_load_dwordx4 v[124:127], v5, s[48:51], s75 offen offset:768 nt
  v_and_b32 v64, v32, v16
  v_and_b32 v65, v32, v17
  v_and_b32 v66, v32, v18
  v_and_b32 v67, v32, v19
  s_waitcnt vmcnt(20)
  v_mfma_f32_16x16x32_bf16 v[40:43], v[56:59], v[128:131], v[40:43]
  buffer_load_dwordx4 v[128:131], v5, s[48:51], s75 offen offset:1024 nt
  v_and_b32 v68, v33, v16
  v_and_b32 v69, v33, v17
  v_and_b32 v70, v33, v18
  v_and_b32 v71, v33, v19
  s_waitcnt vmcnt(20)
  v_mfma_f32_16x16x32_bf16 v[44:47], v[56:59], v[132:135], v[44:47]
  buffer_load_dwordx4 v[132:135], v5, s[48:51], s75 offen offset:1280 nt
  v_and_b32 v72, v34, v16
  v_and_b32 v73, v34, v17
  v_and_b32 v74, v34, v18
  v_and_b32 v75, v34, v19
  s_waitcnt vmcnt(20)
  v_mfma_f32_16x16x32_bf16 v[40:43], v[60:63], v[136:139], v[40:43]
  buffer_load_dwordx4 v[136:139], v5, s[48:51], s75 offen offset:1536 nt
  v_and_b32 v76, v35, v16
  v_and_b32 v77, v35, v17
  v_and_b32 v78, v35, v18
  v_and_b32 v79, v35, v19
  s_waitcnt vmcnt(20)
  v_mfma_f32_16x16x32_bf16 v[44:47], v[60:63], v[140:143], v[44:47]
  buffer_load_dwordx4 v[140:143], v5, s[48:51], s75 offen offset:1792 nt
  s_or_b32 s75, s75, 0xe10000
  s_add_u32 s75, s75, 8192
  s_and_b32 s75, s75, 0xff1ee000
  s_waitcnt vmcnt(20) lgkmcnt(0)
  v_mfma_f32_16x16x32_bf16 v[40:43], v[64:67], v[144:147], v[40:43]
  buffer_load_dwordx4 v[144:147], v5, s[48:51], s75 offen offset:0 nt
  ds_read_b128 v[24:27], v107 offset:4992
  v_fma_f32 v28, v20, s10, v7
  v_fma_f32 v29, v21, s10, v7
  v_fma_f32 v30, v22, s10, v7
  v_fma_f32 v31, v23, s10, v7
  s_waitcnt vmcnt(20)
  v_mfma_f32_16x16x32_bf16 v[44:47], v[64:67], v[148:151], v[44:47]
  buffer_load_dwordx4 v[148:151], v5, s[48:51], s75 offen offset:256 nt
  v_exp_f32 v28, v28
  v_exp_f32 v29, v29
  v_exp_f32 v30, v30
  v_exp_f32 v31, v31
  s_waitcnt vmcnt(20)
  v_mfma_f32_16x16x32_bf16 v[40:43], v[68:71], v[152:155], v[40:43]
  buffer_load_dwordx4 v[152:155], v5, s[48:51], s75 offen offset:512 nt
  v_cvt_pk_bf16_f32 v32, v28, v28
  v_cvt_pk_bf16_f32 v33, v29, v29
  v_cvt_pk_bf16_f32 v34, v30, v30
  v_cvt_pk_bf16_f32 v35, v31, v31
  s_waitcnt vmcnt(20)
  v_mfma_f32_16x16x32_bf16 v[44:47], v[68:71], v[156:159], v[44:47]
  buffer_load_dwordx4 v[156:159], v5, s[48:51], s75 offen offset:768 nt
  v_and_b32 v48, v32, v16
  v_and_b32 v49, v32, v17
  v_and_b32 v50, v32, v18
  v_and_b32 v51, v32, v19
  s_waitcnt vmcnt(20)
  v_mfma_f32_16x16x32_bf16 v[40:43], v[72:75], v[160:163], v[40:43]
  buffer_load_dwordx4 v[160:163], v5, s[48:51], s75 offen offset:1024 nt
  v_and_b32 v52, v33, v16
  v_and_b32 v53, v33, v17
  v_and_b32 v54, v33, v18
  v_and_b32 v55, v33, v19
  s_waitcnt vmcnt(20)
  v_mfma_f32_16x16x32_bf16 v[44:47], v[72:75], v[164:167], v[44:47]
  buffer_load_dwordx4 v[164:167], v5, s[48:51], s75 offen offset:1280 nt
  v_and_b32 v56, v34, v16
  v_and_b32 v57, v34, v17
  v_and_b32 v58, v34, v18
  v_and_b32 v59, v34, v19
  s_waitcnt vmcnt(20)
  v_mfma_f32_16x16x32_bf16 v[40:43], v[76:79], v[168:171], v[40:43]
  buffer_load_dwordx4 v[168:171], v5, s[48:51], s75 offen offset:1536 nt
  v_and_b32 v60, v35, v16
  v_and_b32 v61, v35, v17
  v_and_b32 v62, v35, v18
  v_and_b32 v63, v35, v19
  s_waitcnt vmcnt(20)
  v_mfma_f32_16x16x32_bf16 v[44:47], v[76:79], v[172:175], v[44:47]
  buffer_load_dwordx4 v[172:175], v5, s[48:51], s75 offen offset:1792 nt
  s_or_b32 s75, s75, 0xe10000
  s_add_u32 s75, s75, 8192
  s_and_b32 s75, s75, 0xff1ee000
  s_waitcnt vmcnt(20) lgkmcnt(0)
  v_mfma_f32_16x16x32_bf16 v[40:43], v[48:51], v[176:179], v[40:43]
  buffer_load_dwordx4 v[176:179], v5, s[48:51], s75 offen offset:0 nt
  ds_read_b128 v[20:23], v107 offset:5120
  v_fma_f32 v28, v24, s10, v7
  v_fma_f32 v29, v25, s10, v7
  v_fma_f32 v30, v26, s10, v7
  v_fma_f32 v31, v27, s10, v7
  s_waitcnt vmcnt(20)
  v_mfma_f32_16x16x32_bf16 v[44:47], v[48:51], v[180:183], v[44:47]
  buffer_load_dwordx4 v[180:183], v5, s[48:51], s75 offen offset:256 nt
  v_exp_f32 v28, v28
  v_exp_f32 v29, v29
  v_exp_f32 v30, v30
  v_exp_f32 v31, v31
  s_waitcnt vmcnt(20)
  v_mfma_f32_16x16x32_bf16 v[40:43], v[52:55], v[184:187], v[40:43]
  buffer_load_dwordx4 v[184:187], v5, s[48:51], s75 offen offset:512 nt
  v_cvt_pk_bf16_f32 v32, v28, v28
  v_cvt_pk_bf16_f32 v33, v29, v29
  v_cvt_pk_bf16_f32 v34, v30, v30
  v_cvt_pk_bf16_f32 v35, v31, v31
  s_waitcnt vmcnt(20)
  v_mfma_f32_16x16x32_bf16 v[44:47], v[52:55], v[188:191], v[44:47]
  buffer_load_dwordx4 v[188:191], v5, s[48:51], s75 offen offset:768 nt
  v_and_b32 v64, v32, v16
  v_and_b32 v65, v32, v17
  v_and_b32 v66, v32, v18
  v_and_b32 v67, v32, v19
  s_waitcnt vmcnt(20)
  v_mfma_f32_16x16x32_bf16 v[40:43], v[56:59], v[192:195], v[40:43]
  buffer_load_dwordx4 v[192:195], v5, s[48:51], s75 offen offset:1024 nt
  v_and_b32 v68, v33, v16
  v_and_b32 v69, v33, v17
  v_and_b32 v70, v33, v18
  v_and_b32 v71, v33, v19
  v_add_u32 v243, 1, v243
  ds_write_b32 v15, v243 offset:1032
  ds_read_b32 v248, v15 offset:1036
  s_waitcnt vmcnt(20)
  v_mfma_f32_16x16x32_bf16 v[44:47], v[56:59], v[196:199], v[44:47]
  buffer_load_dwordx4 v[196:199], v5, s[48:51], s75 offen offset:1280 nt
  v_and_b32 v72, v34, v16
  v_and_b32 v73, v34, v17
  v_and_b32 v74, v34, v18
  v_and_b32 v75, v34, v19
  s_waitcnt vmcnt(20)
  v_mfma_f32_16x16x32_bf16 v[40:43], v[60:63], v[200:203], v[40:43]
  buffer_load_dwordx4 v[200:203], v5, s[48:51], s75 offen offset:1536 nt
  v_and_b32 v76, v35, v16
  v_and_b32 v77, v35, v17
  v_and_b32 v78, v35, v18
  v_and_b32 v79, v35, v19
  s_waitcnt vmcnt(20)
  v_mfma_f32_16x16x32_bf16 v[44:47], v[60:63], v[204:207], v[44:47]
  buffer_load_dwordx4 v[204:207], v5, s[48:51], s75 offen offset:1792 nt
  s_or_b32 s75, s75, 0xe10000
  s_add_u32 s75, s75, 8192
  s_and_b32 s75, s75, 0xff1ee000
  s_waitcnt vmcnt(20) lgkmcnt(0)
  v_mfma_f32_16x16x32_bf16 v[40:43], v[64:67], v[208:211], v[40:43]
  buffer_load_dwordx4 v[208:211], v5, s[48:51], s75 offen offset:0 nt
  ds_read_b128 v[24:27], v107 offset:5248
  v_fma_f32 v28, v20, s10, v7
  v_fma_f32 v29, v21, s10, v7
  v_fma_f32 v30, v22, s10, v7
  v_fma_f32 v31, v23, s10, v7
  s_waitcnt vmcnt(20)
  v_mfma_f32_16x16x32_bf16 v[44:47], v[64:67], v[212:215], v[44:47]
  buffer_load_dwordx4 v[212:215], v5, s[48:51], s75 offen offset:256 nt
  v_exp_f32 v28, v28
  v_exp_f32 v29, v29
  v_exp_f32 v30, v30
  v_exp_f32 v31, v31
  s_waitcnt vmcnt(20)
  v_mfma_f32_16x16x32_bf16 v[40:43], v[68:71], v[216:219], v[40:43]
  buffer_load_dwordx4 v[216:219], v5, s[48:51], s75 offen offset:512 nt
  v_cvt_pk_bf16_f32 v32, v28, v28
  v_cvt_pk_bf16_f32 v33, v29, v29
  v_cvt_pk_bf16_f32 v34, v30, v30
  v_cvt_pk_bf16_f32 v35, v31, v31
  s_waitcnt vmcnt(20)
  v_mfma_f32_16x16x32_bf16 v[44:47], v[68:71], v[220:223], v[44:47]
  buffer_load_dwordx4 v[220:223], v5, s[48:51], s75 offen offset:768 nt
  v_and_b32 v48, v32, v16
  v_and_b32 v49, v32, v17
  v_and_b32 v50, v32, v18
  v_and_b32 v51, v32, v19
  s_waitcnt vmcnt(20)
  v_mfma_f32_16x16x32_bf16 v[40:43], v[72:75], v[224:227], v[40:43]
  buffer_load_dwordx4 v[224:227], v5, s[48:51], s75 offen offset:1024 nt
  v_and_b32 v52, v33, v16
  v_and_b32 v53, v33, v17
  v_and_b32 v54, v33, v18
  v_and_b32 v55, v33, v19
  s_waitcnt vmcnt(20)
  v_mfma_f32_16x16x32_bf16 v[44:47], v[72:75], v[228:231], v[44:47]
  buffer_load_dwordx4 v[228:231], v5, s[48:51], s75 offen offset:1280 nt
  v_and_b32 v56, v34, v16
  v_and_b32 v57, v34, v17
  v_and_b32 v58, v34, v18
  v_and_b32 v59, v34, v19
  s_waitcnt vmcnt(20)
  v_mfma_f32_16x16x32_bf16 v[40:43], v[76:79], v[232:235], v[40:43]
  buffer_load_dwordx4 v[232:235], v5, s[48:51], s75 offen offset:1536 nt
  v_and_b32 v60, v35, v16
  v_and_b32 v61, v35, v17
  v_and_b32 v62, v35, v18
  v_and_b32 v63, v35, v19
  s_waitcnt vmcnt(20)
  v_mfma_f32_16x16x32_bf16 v[44:47], v[76:79], v[236:239], v[44:47]
  buffer_load_dwordx4 v[236:239], v5, s[48:51], s75 offen offset:1792 nt
  s_or_b32 s75, s75, 0xe10000
  s_add_u32 s75, s75, 8192
  s_and_b32 s75, s75, 0xff1ee000
  v_add_u32 v107, 512, v107
  s_sub_u32 s11, s11, 1
  s_cmp_eq_u32 s11, 0
  s_cbranch_scc1 L_loop2_done
  v_readfirstlane_b32 s15, v248
  s_nop 3
  s_cmp_eq_u32 s15, 0
  s_cbranch_scc1 L_loop2_0
  s_cmp_eq_u32 s15, 1
  s_cbranch_scc1 L_loop2_1
  s_cmp_eq_u32 s15, 2
  s_cbranch_scc1 L_loop2_2
  s_branch L_loop2_3
L_loop2_2:
  s_waitcnt vmcnt(22) lgkmcnt(0)
  v_mfma_f32_16x16x32_bf16 v[40:43], v[48:51], v[112:115], v[40:43]
  buffer_load_dwordx4 v[112:115], v5, s[48:51], s75 offen offset:0 nt
  ds_read_b128 v[20:23], v107 offset:4864
  v_fma_f32 v28, v24, s10, v7
  v_fma_f32 v29, v25, s10, v7
  v_fma_f32 v30, v26, s10, v7
  v_fma_f32 v31, v27, s10, v7
  s_waitcnt vmcnt(22)
  v_mfma_f32_16x16x32_bf16 v[44:47], v[48:51], v[116:119], v[44:47]
  buffer_load_dwordx4 v[116:119], v5, s[48:51], s75 offen offset:256 nt
  v_exp_f32 v28, v28
  v_exp_f32 v29, v29
  v_exp_f32 v30, v30
  v_exp_f32 v31, v31
  s_waitcnt vmcnt(22)
  v_mfma_f32_16x16x32_bf16 v[40:43], v[52:55], v[120:123], v[40:43]
  buffer_load_dwordx4 v[120:123], v5, s[48:51], s75 offen offset:512 nt
  v_cvt_pk_bf16_f32 v32, v28, v28
  v_cvt_pk_bf16_f32 v33, v29, v29
  v_cvt_pk_bf16_f32 v34, v30, v30
  v_cvt_pk_bf16_f32 v35, v31, v31
  s_waitcnt vmcnt(22)
  v_mfma_f32_16x16x32_bf16 v[44:47], v[52:55], v[124:127], v[44:47]
  buffer_load_dwordx4 v[124:127], v5, s[48:51], s75 offen offset:768 nt
  v_and_b32 v64, v32, v16
  v_and_b32 v65, v32, v17
  v_and_b32 v66, v32, v18
  v_and_b32 v67, v32, v19
  s_waitcnt vmcnt(22)
  v_mfma_f32_16x16x32_bf16 v[40:43], v[56:59], v[128:131], v[40:43]
  buffer_load_dwordx4 v[128:131], v5, s[48:51], s75 offen offset:1024 nt
  v_and_b32 v68, v33, v16
  v_and_b32 v69, v33, v17
  v_and_b32 v70, v33, v18
  v_and_b32 v71, v33, v19
  s_waitcnt vmcnt(22)
  v_mfma_f32_16x16x32_bf16 v[44:47], v[56:59], v[132:135], v[44:47]
  buffer_load_dwordx4 v[132:135], v5, s[48:51], s75 offen offset:1280 nt
  v_and_b32 v72, v34, v16
  v_and_b32 v73, v34, v17
  v_and_b32 v74, v34, v18
  v_and_b32 v75, v34, v19
  s_waitcnt vmcnt(22)
  v_mfma_f32_16x16x32_bf16 v[40:43], v[60:63], v[136:139], v[40:43]
  buffer_load_dwordx4 v[136:139], v5, s[48:51], s75 offen offset:1536 nt
  v_and_b32 v76, v35, v16
  v_and_b32 v77, v35, v17
  v_and_b32 v78, v35, v18
  v_and_b32 v79, v35, v19
  s_waitcnt vmcnt(22)
  v_mfma_f32_16x16x32_bf16 v[44:47], v[60:63], v[140:143], v[44:47]
  buffer_load_dwordx4 v[140:143], v5, s[48:51], s75 offen offset:1792 nt
  s_or_b32 s75, s75, 0xe10000
  s_add_u32 s75, s75, 8192
  s_and_b32 s75, s75, 0xff1ee000
  s_waitcnt vmcnt(22) lgkmcnt(0)
  v_mfma_f32_16x16x32_bf16 v[40:43], v[64:67], v[144:147], v[40:43]
  buffer_load_dwordx4 v[144:147], v5, s[48:51], s75 offen offset:0 nt
  ds_read_b128 v[24:27], v107 offset:4992
  v_fma_f32 v28, v20, s10, v7
  v_fma_f32 v29, v21, s10, v7
  v_fma_f32 v30, v22, s10, v7
  v_fma_f32 v31, v23, s10, v7
  s_waitcnt vmcnt(22)
  v_mfma_f32_16x16x32_bf16 v[44:47], v[64:67], v[148:151], v[44:47]
  buffer_load_dwordx4 v[148:151], v5, s[48:51], s75 offen offset:256 nt
  v_exp_f32 v28, v28
  v_exp_f32 v29, v29
  v_exp_f32 v30, v30
  v_exp_f32 v31, v31
  s_waitcnt vmcnt(22)
  v_mfma_f32_16x16x32_bf16 v[40:43], v[68:71], v[152:155], v[40:43]
  buffer_load_dwordx4 v[152:155], v5, s[48:51], s75 offen offset:512 nt
  v_cvt_pk_bf16_f32 v32, v28, v28
  v_cvt_pk_bf16_f32 v33, v29, v29
  v_cvt_pk_bf16_f32 v34, v30, v30
  v_cvt_pk_bf16_f32 v35, v31, v31
  s_waitcnt vmcnt(22)
  v_mfma_f32_16x16x32_bf16 v[44:47], v[68:71], v[156:159], v[44:47]
  buffer_load_dwordx4 v[156:159], v5, s[48:51], s75 offen offset:768 nt
  v_and_b32 v48, v32, v16
  v_and_b32 v49, v32, v17
  v_and_b32 v50, v32, v18
  v_and_b32 v51, v32, v19
  s_waitcnt vmcnt(22)
  v_mfma_f32_16x16x32_bf16 v[40:43], v[72:75], v[160:163], v[40:43]
  buffer_load_dwordx4 v[160:163], v5, s[48:51], s75 offen offset:1024 nt
  v_and_b32 v52, v33, v16
  v_and_b32 v53, v33, v17
  v_and_b32 v54, v33, v18
  v_and_b32 v55, v33, v19
  s_waitcnt vmcnt(22)
  v_mfma_f32_16x16x32_bf16 v[44:47], v[72:75], v[164:167], v[44:47]
  buffer_load_dwordx4 v[164:167], v5, s[48:51], s75 offen offset:1280 nt
  v_and_b32 v56, v34, v16
  v_and_b32 v57, v34, v17
  v_and_b32 v58, v34, v18
  v_and_b32 v59, v34, v19
  s_waitcnt vmcnt(22)
  v_mfma_f32_16x16x32_bf16 v[40:43], v[76:79], v[168:171], v[40:43]
  buffer_load_dwordx4 v[168:171], v5, s[48:51], s75 offen offset:1536 nt
  v_and_b32 v60, v35, v16
  v_and_b32 v61, v35, v17
  v_and_b32 v62, v35, v18
  v_and_b32 v63, v35, v19
  s_waitcnt vmcnt(22)
  v_mfma_f32_16x16x32_bf16 v[44:47], v[76:79], v[172:175], v[44:47]
  buffer_load_dwordx4 v[172:175], v5, s[48:51], s75 offen offset:1792 nt
  s_or_b32 s75, s75, 0xe10000
  s_add_u32 s75, s75, 8192
  s_and_b32 s75, s75, 0xff1ee000
  s_waitcnt vmcnt(22) lgkmcnt(0)
  v_mfma_f32_16x16x32_bf16 v[40:43], v[48:51], v[176:179], v[40:43]
  buffer_load_dwordx4 v[176:179], v5, s[48:51], s75 offen offset:0 nt
  ds_read_b128 v[20:23], v107 offset:5120
  v_fma_f32 v28, v24, s10, v7
  v_fma_f32 v29, v25, s10, v7
  v_fma_f32 v30, v26, s10, v7
  v_fma_f32 v31, v27, s10, v7
  s_waitcnt vmcnt(22)
  v_mfma_f32_16x16x32_bf16 v[44:47], v[48:51], v[180:183], v[44:47]
  buffer_load_dwordx4 v[180:183], v5, s[48:51], s75 offen offset:256 nt
  v_exp_f32 v28, v28
  v_exp_f32 v29, v29
  v_exp_f32 v30, v30
  v_exp_f32 v31, v31
  s_waitcnt vmcnt(22)
  v_mfma_f32_16x16x32_bf16 v[40:43], v[52:55], v[184:187], v[40:43]
  buffer_load_dwordx4 v[184:187], v5, s[48:51], s75 offen offset:512 nt
  v_cvt_pk_bf16_f32 v32, v28, v28
  v_cvt_pk_bf16_f32 v33, v29, v29
  v_cvt_pk_bf16_f32 v34, v30, v30
  v_cvt_pk_bf16_f32 v35, v31, v31
  s_waitcnt vmcnt(22)
  v_mfma_f32_16x16x32_bf16 v[44:47], v[52:55], v[188:191], v[44:47]
  buffer_load_dwordx4 v[188:191], v5, s[48:51], s75 offen offset:768 nt
  v_and_b32 v64, v32, v16
  v_and_b32 v65, v32, v17
  v_and_b32 v66, v32, v18
  v_and_b32 v67, v32, v19
  s_waitcnt vmcnt(22)
  v_mfma_f32_16x16x32_bf16 v[40:43], v[56:59], v[192:195], v[40:43]
  buffer_load_dwordx4 v[192:195], v5, s[48:51], s75 offen offset:1024 nt
  v_and_b32 v68, v33, v16
  v_and_b32 v69, v33, v17
  v_and_b32 v70, v33, v18
  v_and_b32 v71, v33, v19
  v_add_u32 v243, 1, v243
  ds_write_b32 v15, v243 offset:1032
  ds_read_b32 v248, v15 offset:1036
  s_waitcnt vmcnt(22)
  v_mfma_f32_16x16x32_bf16 v[44:47], v[56:59], v[196:199], v[44:47]
  buffer_load_dwordx4 v[196:199], v5, s[48:51], s75 offen offset:1280 nt
  v_and_b32 v72, v34, v16
  v_and_b32 v73, v34, v17
  v_and_b32 v74, v34, v18
  v_and_b32 v75, v34, v19
  s_waitcnt vmcnt(22)
  v_mfma_f32_16x16x32_bf16 v[40:43], v[60:63], v[200:203], v[40:43]
  buffer_load_dwordx4 v[200:203], v5, s[48:51], s75 offen offset:1536 nt
  v_and_b32 v76, v35, v16
  v_and_b32 v77, v35, v17
  v_and_b32 v78, v35, v18
  v_and_b32 v79, v35, v19
  s_waitcnt vmcnt(22)
  v_mfma_f32_16x16x32_bf16 v[44:47], v[60:63], v[204:207], v[44:47]
  buffer_load_dwordx4 v[204:207], v5, s[48:51], s75 offen offset:1792 nt
  s_or_b32 s75, s75, 0xe10000
  s_add_u32 s75, s75, 8192
  s_and_b32 s75, s75, 0xff1ee000
  s_waitcnt vmcnt(22) lgkmcnt(0)
  v_mfma_f32_16x16x32_bf16 v[40:43], v[64:67], v[208:211], v[40:43]
  buffer_load_dwordx4 v[208:211], v5, s[48:51], s75 offen offset:0 nt
  ds_read_b128 v[24:27], v107 offset:5248
  v_fma_f32 v28, v20, s10, v7
  v_fma_f32 v29, v21, s10, v7
  v_fma_f32 v30, v22, s10, v7
  v_fma_f32 v31, v23, s10, v7
  s_waitcnt vmcnt(22)
  v_mfma_f32_16x16x32_bf16 v[44:47], v[64:67], v[212:215], v[44:47]
  buffer_load_dwordx4 v[212:215], v5, s[48:51], s75 offen offset:256 nt
  v_exp_f32 v28, v28
  v_exp_f32 v29, v29
  v_exp_f32 v30, v30
  v_exp_f32 v31, v31
  s_waitcnt vmcnt(22)
  v_mfma_f32_16x16x32_bf16 v[40:43], v[68:71], v[216:219], v[40:43]
  buffer_load_dwordx4 v[216:219], v5, s[48:51], s75 offen offset:512 nt
  v_cvt_pk_bf16_f32 v32, v28, v28
  v_cvt_pk_bf16_f32 v33, v29, v29
  v_cvt_pk_bf16_f32 v34, v30, v30
  v_cvt_pk_bf16_f32 v35, v31, v31
  s_waitcnt vmcnt(22)
  v_mfma_f32_16x16x32_bf16 v[44:47], v[68:71], v[220:223], v[44:47]
  buffer_load_dwordx4 v[220:223], v5, s[48:51], s75 offen offset:768 nt
  v_and_b32 v48, v32, v16
  v_and_b32 v49, v32, v17
  v_and_b32 v50, v32, v18
  v_and_b32 v51, v32, v19
  s_waitcnt vmcnt(22)
  v_mfma_f32_16x16x32_bf16 v[40:43], v[72:75], v[224:227], v[40:43]
  buffer_load_dwordx4 v[224:227], v5, s[48:51], s75 offen offset:1024 nt
  v_and_b32 v52, v33, v16
  v_and_b32 v53, v33, v17
  v_and_b32 v54, v33, v18
  v_and_b32 v55, v33, v19
  s_waitcnt vmcnt(22)
  v_mfma_f32_16x16x32_bf16 v[44:47], v[72:75], v[228:231], v[44:47]
  buffer_load_dwordx4 v[228:231], v5, s[48:51], s75 offen offset:1280 nt
  v_and_b32 v56, v34, v16
  v_and_b32 v57, v34, v17
  v_and_b32 v58, v34, v18
  v_and_b32 v59, v34, v19
  s_waitcnt vmcnt(22)
  v_mfma_f32_16x16x32_bf16 v[40:43], v[76:79], v[232:235], v[40:43]
  buffer_load_dwordx4 v[232:235], v5, s[48:51], s75 offen offset:1536 nt
  v_and_b32 v60, v35, v16
  v_and_b32 v61, v35, v17
  v_and_b32 v62, v35, v18
  v_and_b32 v63, v35, v19
  s_waitcnt vmcnt(22)
  v_mfma_f32_16x16x32_bf16 v[44:47], v[76:79], v[236:239], v[44:47]
  buffer_load_dwordx4 v[236:239], v5, s[48:51], s75 offen offset:1792 nt
  s_or_b32 s75, s75, 0xe10000
  s_add_u32 s75, s75, 8192
  s_and_b32 s75, s75, 0xff1ee000
  v_add_u32 v107, 512, v107
  s_sub_u32 s11, s11, 1
  s_cmp_eq_u32 s11, 0
  s_cbranch_scc1 L_loop2_done
  v_readfirstlane_b32 s15, v248
  s_nop 3
  s_cmp_eq_u32 s15, 0
  s_cbranch_scc1 L_loop2_0
  s_cmp_eq_u32 s15, 1
  s_cbranch_scc1 L_loop2_1
  s_cmp_eq_u32 s15, 2
  s_cbranch_scc1 L_loop2_2
  s_branch L_loop2_3
L_loop2_3:
  s_waitcnt vmcnt(26) lgkmcnt(0)
  v_mfma_f32_16x16x32_bf16 v[40:43], v[48:51], v[112:115], v[40:43]
  buffer_load_dwordx4 v[112:115], v5, s[48:51], s75 offen offset:0 nt
  ds_read_b128 v[20:23], v107 offset:4864
  v_fma_f32 v28, v24, s10, v7
  v_fma_f32 v29, v25, s10, v7
  v_fma_f32 v30, v26, s10, v7
  v_fma_f32 v31, v27, s10, v7
  s_waitcnt vmcnt(26)
  v_mfma_f32_16x16x32_bf16 v[44:47], v[48:51], v[116:119], v[44:47]
  buffer_load_dwordx4 v[116:119], v5, s[48:51], s75 offen offset:256 nt
  v_exp_f32 v28, v28
  v_exp_f32 v29, v29
  v_exp_f32 v30, v30
  v_exp_f32 v31, v31
  s_waitcnt vmcnt(26)
  v_mfma_f32_16x16x32_bf16 v[40:43], v[52:55], v[120:123], v[40:43]
  buffer_load_dwordx4 v[120:123], v5, s[48:51], s75 offen offset:512 nt
  v_cvt_pk_bf16_f32 v32, v28, v28
  v_cvt_pk_bf16_f32 v33, v29, v29
  v_cvt_pk_bf16_f32 v34, v30, v30
  v_cvt_pk_bf16_f32 v35, v31, v31
  s_waitcnt vmcnt(26)
  v_mfma_f32_16x16x32_bf16 v[44:47], v[52:55], v[124:127], v[44:47]
  buffer_load_dwordx4 v[124:127], v5, s[48:51], s75 offen offset:768 nt
  v_and_b32 v64, v32, v16
  v_and_b32 v65, v32, v17
  v_and_b32 v66, v32, v18
  v_and_b32 v67, v32, v19
  s_waitcnt vmcnt(26)
  v_mfma_f32_16x16x32_bf16 v[40:43], v[56:59], v[128:131], v[40:43]
  buffer_load_dwordx4 v[128:131], v5, s[48:51], s75 offen offset:1024 nt
  v_and_b32 v68, v33, v16
  v_and_b32 v69, v33, v17
  v_and_b32 v70, v33, v18
  v_and_b32 v71, v33, v19
  s_waitcnt vmcnt(26)
  v_mfma_f32_16x16x32_bf16 v[44:47], v[56:59], v[132:135], v[44:47]
  buffer_load_dwordx4 v[132:135], v5, s[48:51], s75 offen offset:1280 nt
  v_and_b32 v72, v34, v16
  v_and_b32 v73, v34, v17
  v_and_b32 v74, v34, v18
  v_and_b32 v75, v34, v19
  s_waitcnt vmcnt(26)
  v_mfma_f32_16x16x32_bf16 v[40:43], v[60:63], v[136:139], v[40:43]
  buffer_load_dwordx4 v[136:139], v5, s[48:51], s75 offen offset:1536 nt
  v_and_b32 v76, v35, v16
  v_and_b32 v77, v35, v17
  v_and_b32 v78, v35, v18
  v_and_b32 v79, v35, v19
  s_waitcnt vmcnt(26)
  v_mfma_f32_16x16x32_bf16 v[44:47], v[60:63], v[140:143], v[44:47]
  buffer_load_dwordx4 v[140:143], v5, s[48:51], s75 offen offset:1792 nt
  s_or_b32 s75, s75, 0xe10000
  s_add_u32 s75, s75, 8192
  s_and_b32 s75, s75, 0xff1ee000
  s_waitcnt vmcnt(26) lgkmcnt(0)
  v_mfma_f32_16x16x32_bf16 v[40:43], v[64:67], v[144:147], v[40:43]
  buffer_load_dwordx4 v[144:147], v5, s[48:51], s75 offen offset:0 nt
  ds_read_b128 v[24:27], v107 offset:4992
  v_fma_f32 v28, v20, s10, v7
  v_fma_f32 v29, v21, s10, v7
  v_fma_f32 v30, v22, s10, v7
  v_fma_f32 v31, v23, s10, v7
  s_waitcnt vmcnt(26)
  v_mfma_f32_16x16x32_bf16 v[44:47], v[64:67], v[148:151], v[44:47]
  buffer_load_dwordx4 v[148:151], v5, s[48:51], s75 offen offset:256 nt
  v_exp_f32 v28, v28
  v_exp_f32 v29, v29
  v_exp_f32 v30, v30
  v_exp_f32 v31, v31
  s_waitcnt vmcnt(26)
  v_mfma_f32_16x16x32_bf16 v[40:43], v[68:71], v[152:155], v[40:43]
  buffer_load_dwordx4 v[152:155], v5, s[48:51], s75 offen offset:512 nt
  v_cvt_pk_bf16_f32 v32, v28, v28
  v_cvt_pk_bf16_f32 v33, v29, v29
  v_cvt_pk_bf16_f32 v34, v30, v30
  v_cvt_pk_bf16_f32 v35, v31, v31
  s_waitcnt vmcnt(26)
  v_mfma_f32_16x16x32_bf16 v[44:47], v[68:71], v[156:159], v[44:47]
  buffer_load_dwordx4 v[156:159], v5, s[48:51], s75 offen offset:768 nt
  v_and_b32 v48, v32, v16
  v_and_b32 v49, v32, v17
  v_and_b32 v50, v32, v18
  v_and_b32 v51, v32, v19
  s_waitcnt vmcnt(26)
  v_mfma_f32_16x16x32_bf16 v[40:43], v[72:75], v[160:163], v[40:43]
  buffer_load_dwordx4 v[160:163], v5, s[48:51], s75 offen offset:1024 nt
  v_and_b32 v52, v33, v16
  v_and_b32 v53, v33, v17
  v_and_b32 v54, v33, v18
  v_and_b32 v55, v33, v19
  s_waitcnt vmcnt(26)
  v_mfma_f32_16x16x32_bf16 v[44:47], v[72:75], v[164:167], v[44:47]
  buffer_load_dwordx4 v[164:167], v5, s[48:51], s75 offen offset:1280 nt
  v_and_b32 v56, v34, v16
  v_and_b32 v57, v34, v17
  v_and_b32 v58, v34, v18
  v_and_b32 v59, v34, v19
  s_waitcnt vmcnt(26)
  v_mfma_f32_16x16x32_bf16 v[40:43], v[76:79], v[168:171], v[40:43]
  buffer_load_dwordx4 v[168:171], v5, s[48:51], s75 offen offset:1536 nt
  v_and_b32 v60, v35, v16
  v_and_b32 v61, v35, v17
  v_and_b32 v62, v35, v18
  v_and_b32 v63, v35, v19
  s_waitcnt vmcnt(26)
  v_mfma_f32_16x16x32_bf16 v[44:47], v[76:79], v[172:175], v[44:47]
  buffer_load_dwordx4 v[172:175], v5, s[48:51], s75 offen offset:1792 nt
  s_or_b32 s75, s75, 0xe10000
  s_add_u32 s75, s75, 8192
  s_and_b32 s75, s75, 0xff1ee000
  s_waitcnt vmcnt(26) lgkmcnt(0)
  v_mfma_f32_16x16x32_bf16 v[40:43], v[48:51], v[176:179], v[40:43]
  buffer_load_dwordx4 v[176:179], v5, s[48:51], s75 offen offset:0 nt
  ds_read_b128 v[20:23], v107 offset:5120
  v_fma_f32 v28, v24, s10, v7
  v_fma_f32 v29, v25, s10, v7
  v_fma_f32 v30, v26, s10, v7
  v_fma_f32 v31, v27, s10, v7
  s_waitcnt vmcnt(26)
  v_mfma_f32_16x16x32_bf16 v[44:47], v[48:51], v[180:183], v[44:47]
  buffer_load_dwordx4 v[180:183], v5, s[48:51], s75 offen offset:256 nt
  v_exp_f32 v28, v28
  v_exp_f32 v29, v29
  v_exp_f32 v30, v30
  v_exp_f32 v31, v31
  s_waitcnt vmcnt(26)
  v_mfma_f32_16x16x32_bf16 v[40:43], v[52:55], v[184:187], v[40:43]
  buffer_load_dwordx4 v[184:187], v5, s[48:51], s75 offen offset:512 nt
  v_cvt_pk_bf16_f32 v32, v28, v28
  v_cvt_pk_bf16_f32 v33, v29, v29
  v_cvt_pk_bf16_f32 v34, v30, v30
  v_cvt_pk_bf16_f32 v35, v31, v31
  s_waitcnt vmcnt(26)
  v_mfma_f32_16x16x32_bf16 v[44:47], v[52:55], v[188:191], v[44:47]
  buffer_load_dwordx4 v[188:191], v5, s[48:51], s75 offen offset:768 nt
  v_and_b32 v64, v32, v16
  v_and_b32 v65, v32, v17
  v_and_b32 v66, v32, v18
  v_and_b32 v67, v32, v19
  s_waitcnt vmcnt(26)
  v_mfma_f32_16x16x32_bf16 v[40:43], v[56:59], v[192:195], v[40:43]
  buffer_load_dwordx4 v[192:195], v5, s[48:51], s75 offen offset:1024 nt
  v_and_b32 v68, v33, v16
  v_and_b32 v69, v33, v17
  v_and_b32 v70, v33, v18
  v_and_b32 v71, v33, v19
  v_add_u32 v243, 1, v243
  ds_write_b32 v15, v243 offset:1032
  ds_read_b32 v248, v15 offset:1036
  s_waitcnt vmcnt(26)
  v_mfma_f32_16x16x32_bf16 v[44:47], v[56:59], v[196:199], v[44:47]
  buffer_load_dwordx4 v[196:199], v5, s[48:51], s75 offen offset:1280 nt
  v_and_b32 v72, v34, v16
  v_and_b32 v73, v34, v17
  v_and_b32 v74, v34, v18
  v_and_b32 v75, v34, v19
  s_waitcnt vmcnt(26)
  v_mfma_f32_16x16x32_bf16 v[40:43], v[60:63], v[200:203], v[40:43]
  buffer_load_dwordx4 v[200:203], v5, s[48:51], s75 offen offset:1536 nt
  v_and_b32 v76, v35, v16
  v_and_b32 v77, v35, v17
  v_and_b32 v78, v35, v18
  v_and_b32 v79, v35, v19
  s_waitcnt vmcnt(26)
  v_mfma_f32_16x16x32_bf16 v[44:47], v[60:63], v[204:207], v[44:47]
  buffer_load_dwordx4 v[204:207], v5, s[48:51], s75 offen offset:1792 nt
  s_or_b32 s75, s75, 0xe10000
  s_add_u32 s75, s75, 8192
  s_and_b32 s75, s75, 0xff1ee000
  s_waitcnt vmcnt(26) lgkmcnt(0)
  v_mfma_f32_16x16x32_bf16 v[40:43], v[64:67], v[208:211], v[40:43]
  buffer_load_dwordx4 v[208:211], v5, s[48:51], s75 offen offset:0 nt
  ds_read_b128 v[24:27], v107 offset:5248
  v_fma_f32 v28, v20, s10, v7
  v_fma_f32 v29, v21, s10, v7
  v_fma_f32 v30, v22, s10, v7
  v_fma_f32 v31, v23, s10, v7
  s_waitcnt vmcnt(26)
  v_mfma_f32_16x16x32_bf16 v[44:47], v[64:67], v[212:215], v[44:47]
  buffer_load_dwordx4 v[212:215], v5, s[48:51], s75 offen offset:256 nt
  v_exp_f32 v28, v28
  v_exp_f32 v29, v29
  v_exp_f32 v30, v30
  v_exp_f32 v31, v31
  s_waitcnt vmcnt(26)
  v_mfma_f32_16x16x32_bf16 v[40:43], v[68:71], v[216:219], v[40:43]
  buffer_load_dwordx4 v[216:219], v5, s[48:51], s75 offen offset:512 nt
  v_cvt_pk_bf16_f32 v32, v28, v28
  v_cvt_pk_bf16_f32 v33, v29, v29
  v_cvt_pk_bf16_f32 v34, v30, v30
  v_cvt_pk_bf16_f32 v35, v31, v31
  s_waitcnt vmcnt(26)
  v_mfma_f32_16x16x32_bf16 v[44:47], v[68:71], v[220:223], v[44:47]
  buffer_load_dwordx4 v[220:223], v5, s[48:51], s75 offen offset:768 nt
  v_and_b32 v48, v32, v16
  v_and_b32 v49, v32, v17
  v_and_b32 v50, v32, v18
  v_and_b32 v51, v32, v19
  s_waitcnt vmcnt(26)
  v_mfma_f32_16x16x32_bf16 v[40:43], v[72:75], v[224:227], v[40:43]
  buffer_load_dwordx4 v[224:227], v5, s[48:51], s75 offen offset:1024 nt
  v_and_b32 v52, v33, v16
  v_and_b32 v53, v33, v17
  v_and_b32 v54, v33, v18
  v_and_b32 v55, v33, v19
  s_waitcnt vmcnt(26)
  v_mfma_f32_16x16x32_bf16 v[44:47], v[72:75], v[228:231], v[44:47]
  buffer_load_dwordx4 v[228:231], v5, s[48:51], s75 offen offset:1280 nt
  v_and_b32 v56, v34, v16
  v_and_b32 v57, v34, v17
  v_and_b32 v58, v34, v18
  v_and_b32 v59, v34, v19
  s_waitcnt vmcnt(26)
  v_mfma_f32_16x16x32_bf16 v[40:43], v[76:79], v[232:235], v[40:43]
  buffer_load_dwordx4 v[232:235], v5, s[48:51], s75 offen offset:1536 nt
  v_and_b32 v60, v35, v16
  v_and_b32 v61, v35, v17
  v_and_b32 v62, v35, v18
  v_and_b32 v63, v35, v19
  s_waitcnt vmcnt(26)
  v_mfma_f32_16x16x32_bf16 v[44:47], v[76:79], v[236:239], v[44:47]
  buffer_load_dwordx4 v[236:239], v5, s[48:51], s75 offen offset:1792 nt
  s_or_b32 s75, s75, 0xe10000
  s_add_u32 s75, s75, 8192
  s_and_b32 s75, s75, 0xff1ee000
  v_add_u32 v107, 512, v107
  s_sub_u32 s11, s11, 1
  s_cmp_eq_u32 s11, 0
  s_cbranch_scc1 L_loop2_done
  v_readfirstlane_b32 s15, v248
  s_nop 3
  s_cmp_eq_u32 s15, 0
  s_cbranch_scc1 L_loop2_0
  s_cmp_eq_u32 s15, 1
  s_cbranch_scc1 L_loop2_1
  s_cmp_eq_u32 s15, 2
  s_cbranch_scc1 L_loop2_2
  s_branch L_loop2_3
L_loop2_done:
  ds_read_b32 v110, v15 offset:1048
  ds_read_b32 v111, v241 offset:1040
  s_waitcnt vmcnt(31) lgkmcnt(0)
  v_mfma_f32_16x16x32_bf16 v[40:43], v[48:51], v[112:115], v[40:43]
  ds_read_b128 v[20:23], v107 offset:4864
  v_fma_f32 v28, v24, s10, v7
  v_fma_f32 v29, v25, s10, v7
  v_fma_f32 v30, v26, s10, v7
  v_fma_f32 v31, v27, s10, v7
  s_waitcnt vmcnt(30)
  v_mfma_f32_16x16x32_bf16 v[44:47], v[48:51], v[116:119], v[44:47]
  v_exp_f32 v28, v28
  v_exp_f32 v29, v29
  v_exp_f32 v30, v30
  v_exp_f32 v31, v31
  s_waitcnt vmcnt(29)
  v_mfma_f32_16x16x32_bf16 v[40:43], v[52:55], v[120:123], v[40:43]
  v_cvt_pk_bf16_f32 v32, v28, v28
  v_cvt_pk_bf16_f32 v33, v29, v29
  v_cvt_pk_bf16_f32 v34, v30, v30
  v_cvt_pk_bf16_f32 v35, v31, v31
  s_waitcnt vmcnt(28)
  v_mfma_f32_16x16x32_bf16 v[44:47], v[52:55], v[124:127], v[44:47]
  v_and_b32 v64, v32, v16
  v_and_b32 v65, v32, v17
  v_and_b32 v66, v32, v18
  v_and_b32 v67, v32, v19
  s_waitcnt vmcnt(27)
  v_mfma_f32_16x16x32_bf16 v[40:43], v[56:59], v[128:131], v[40:43]
  v_and_b32 v68, v33, v16
  v_and_b32 v69, v33, v17
  v_and_b32 v70, v33, v18
  v_and_b32 v71, v33, v19
  s_waitcnt vmcnt(26)
  v_mfma_f32_16x16x32_bf16 v[44:47], v[56:59], v[132:135], v[44:47]
  v_and_b32 v72, v34, v16
  v_and_b32 v73, v34, v17
  v_and_b32 v74, v34, v18
  v_and_b32 v75, v34, v19
  s_waitcnt vmcnt(25)
  v_mfma_f32_16x16x32_bf16 v[40:43], v[60:63], v[136:139], v[40:43]
  v_and_b32 v76, v35, v16
  v_and_b32 v77, v35, v17
  v_and_b32 v78, v35, v18
  v_and_b32 v79, v35, v19
  s_waitcnt vmcnt(24)
  v_mfma_f32_16x16x32_bf16 v[44:47], v[60:63], v[140:143], v[44:47]
  s_waitcnt vmcnt(23) lgkmcnt(0)
  v_mfma_f32_16x16x32_bf16 v[40:43], v[64:67], v[144:147], v[40:43]
  ds_read_b128 v[24:27], v107 offset:4992
  v_fma_f32 v28, v20, s10, v7
  v_fma_f32 v29, v21, s10, v7
  v_fma_f32 v30, v22, s10, v7
  v_fma_f32 v31, v23, s10, v7
  s_waitcnt vmcnt(22)
  v_mfma_f32_16x16x32_bf16 v[44:47], v[64:67], v[148:151], v[44:47]
  v_exp_f32 v28, v28
  v_exp_f32 v29, v29
  v_exp_f32 v30, v30
  v_exp_f32 v31, v31
  s_waitcnt vmcnt(21)
  v_mfma_f32_16x16x32_bf16 v[40:43], v[68:71], v[152:155], v[40:43]
  v_cvt_pk_bf16_f32 v32, v28, v28
  v_cvt_pk_bf16_f32 v33, v29, v29
  v_cvt_pk_bf16_f32 v34, v30, v30
  v_cvt_pk_bf16_f32 v35, v31, v31
  s_waitcnt vmcnt(20)
  v_mfma_f32_16x16x32_bf16 v[44:47], v[68:71], v[156:159], v[44:47]
  v_and_b32 v48, v32, v16
  v_and_b32 v49, v32, v17
  v_and_b32 v50, v32, v18
  v_and_b32 v51, v32, v19
  s_waitcnt vmcnt(19)
  v_mfma_f32_16x16x32_bf16 v[40:43], v[72:75], v[160:163], v[40:43]
  v_and_b32 v52, v33, v16
  v_and_b32 v53, v33, v17
  v_and_b32 v54, v33, v18
  v_and_b32 v55, v33, v19
  s_waitcnt vmcnt(18)
  v_mfma_f32_16x16x32_bf16 v[44:47], v[72:75], v[164:167], v[44:47]
  v_and_b32 v56, v34, v16
  v_and_b32 v57, v34, v17
  v_and_b32 v58, v34, v18
  v_and_b32 v59, v34, v19
  s_waitcnt vmcnt(17)
  v_mfma_f32_16x16x32_bf16 v[40:43], v[76:79], v[168:171], v[40:43]
  v_and_b32 v60, v35, v16
  v_and_b32 v61, v35, v17
  v_and_b32 v62, v35, v18
  v_and_b32 v63, v35, v19
  s_waitcnt vmcnt(16)
  v_mfma_f32_16x16x32_bf16 v[44:47], v[76:79], v[172:175], v[44:47]
  v_mov_b32 v9, 2
  ds_write_b32 v15, v9 offset:1028
  s_waitcnt vmcnt(15) lgkmcnt(0)
  v_mfma_f32_16x16x32_bf16 v[40:43], v[48:51], v[176:179], v[40:43]
  v_fma_f32 v28, v24, s10, v7
  v_fma_f32 v29, v25, s10, v7
  v_fma_f32 v30, v26, s10, v7
  v_fma_f32 v31, v27, s10, v7
  s_waitcnt vmcnt(14)
  v_mfma_f32_16x16x32_bf16 v[44:47], v[48:51], v[180:183], v[44:47]
  v_exp_f32 v28, v28
  v_exp_f32 v29, v29
  v_exp_f32 v30, v30
  v_exp_f32 v31, v31
  v_readfirstlane_b32 s72, v110
  s_waitcnt vmcnt(13)
  v_mfma_f32_16x16x32_bf16 v[40:43], v[52:55], v[184:187], v[40:43]
  v_cvt_pk_bf16_f32 v32, v28, v28
  v_cvt_pk_bf16_f32 v33, v29, v29
  v_cvt_pk_bf16_f32 v34, v30, v30
  v_cvt_pk_bf16_f32 v35, v31, v31
  s_waitcnt vmcnt(12)
  v_mfma_f32_16x16x32_bf16 v[44:47], v[52:55], v[188:191], v[44:47]
  v_and_b32 v64, v32, v16
  v_and_b32 v65, v32, v17
  v_and_b32 v66, v32, v18
  v_and_b32 v67, v32, v19
  s_waitcnt vmcnt(11)
  v_mfma_f32_16x16x32_bf16 v[40:43], v[56:59], v[192:195], v[40:43]
  v_and_b32 v68, v33, v16
  v_and_b32 v69, v33, v17
  v_and_b32 v70, v33, v18
  v_and_b32 v71, v33, v19
  s_waitcnt vmcnt(10)
  v_mfma_f32_16x16x32_bf16 v[44:47], v[56:59], v[196:199], v[44:47]
  v_and_b32 v72, v34, v16
  v_and_b32 v73, v34, v17
  v_and_b32 v74, v34, v18
  v_and_b32 v75, v34, v19
  s_waitcnt vmcnt(9)
  v_mfma_f32_16x16x32_bf16 v[40:43], v[60:63], v[200:203], v[40:43]
  v_and_b32 v76, v35, v16
  v_and_b32 v77, v35, v17
  v_and_b32 v78, v35, v18
  v_and_b32 v79, v35, v19
  s_waitcnt vmcnt(8)
  v_mfma_f32_16x16x32_bf16 v[44:47], v[60:63], v[204:207], v[44:47]
  s_waitcnt vmcnt(7) lgkmcnt(0)
  v_mfma_f32_16x16x32_bf16 v[40:43], v[64:67], v[208:211], v[40:43]
  s_waitcnt vmcnt(6)
  v_mfma_f32_16x16x32_bf16 v[44:47], v[64:67], v[212:215], v[44:47]
  s_waitcnt vmcnt(5)
  v_mfma_f32_16x16x32_bf16 v[40:43], v[68:71], v[216:219], v[40:43]
  s_waitcnt vmcnt(4)
  v_mfma_f32_16x16x32_bf16 v[44:47], v[68:71], v[220:223], v[44:47]
  s_waitcnt vmcnt(3)
  v_mfma_f32_16x16x32_bf16 v[40:43], v[72:75], v[224:227], v[40:43]
  s_waitcnt vmcnt(2)
  v_mfma_f32_16x16x32_bf16 v[44:47], v[72:75], v[228:231], v[44:47]
  s_waitcnt vmcnt(1)
  v_mfma_f32_16x16x32_bf16 v[40:43], v[76:79], v[232:235], v[40:43]
  s_waitcnt vmcnt(0)
  v_mfma_f32_16x16x32_bf16 v[44:47], v[76:79], v[236:239], v[44:47]
  s_cmp_eq_u32 s72, 1
  s_cbranch_scc0 L_faclate
L_facok:
  s_nop 3
  v_mul_f32 v40, v40, v111
  v_mul_f32 v41, v41, v111
  v_mul_f32 v42, v42, v111
  v_mul_f32 v43, v43, v111
  v_perm_b32 v96, v40, v106, s96
  v_perm_b32 v97, v41, v106, s97
  v_perm_b32 v98, v42, v106, s98
  v_perm_b32 v99, v43, v106, s99
  buffer_store_dwordx4 v[96:99], v240, s[52:55], s70 offen sc1
  v_mul_f32 v44, v44, v111
  v_mul_f32 v45, v45, v111
  v_mul_f32 v46, v46, v111
  v_mul_f32 v47, v47, v111
  v_perm_b32 v100, v44, v106, s96
  v_perm_b32 v101, v45, v106, s97
  v_perm_b32 v102, v46, v106, s98
  v_perm_b32 v103, v47, v106, s99
  buffer_store_dwordx4 v[100:103], v240, s[52:55], s71 offen sc1
  v_mov_b32 v9, 3
  ds_write_b32 v15, v9 offset:1028
  s_waitcnt lgkmcnt(0)
  s_branch L_end
L_faclate:
  s_mov_b32 s61, 3200000
L_w1:
  ds_read_b32 v9, v15 offset:1048
  s_waitcnt lgkmcnt(0)
  v_readfirstlane_b32 s15, v9
  s_nop 3
  s_cmp_ge_u32 s15, 1
  s_cbranch_scc1 L_w1_ok
  s_sleep 1
  s_sub_u32 s61, s61, 1
  s_cmp_lg_u32 s61, 0
  s_cbranch_scc1 L_w1
L_w1_ok:
  ds_read_b32 v111, v241 offset:1040
  s_waitcnt lgkmcnt(0)
  s_branch L_facok
L_helper_rest:
  v_lshlrev_b32 v105, 4, v1
  s_mov_b32 s10, 0x3db8aa3b
  s_mov_b32 s64, 0
  s_mov_b32 s65, -1
  s_bfe_u32 s8, s2, 0x30000
  s_lshl_b32 s8, s8, 21
  s_bfe_u32 s15, s2, 0x10003
  s_lshl_b32 s15, s15, 16
  s_or_b32 s8, s8, s15
  s_bfe_u32 s15, s2, 0x40004
  s_lshl_b32 s15, s15, 24
  s_or_b32 s8, s8, s15
  s_lshr_b32 s6, s8, 24
  s_mov_b32 s7, 0
  s_bfe_u32 s15, s2, 0x10000
  s_lshl_b32 s15, s15, 0
  s_or_b32 s7, s7, s15
  s_bfe_u32 s15, s2, 0x10001
  s_lshl_b32 s15, s15, 1
  s_or_b32 s7, s7, s15
  s_bfe_u32 s15, s2, 0x10002
  s_lshl_b32 s15, s15, 2
  s_or_b32 s7, s7, s15
  s_bfe_u32 s15, s2, 0x10003
  s_lshl_b32 s15, s15, 3
  s_or_b32 s7, s7, s15
  s_mov_b32 s56, s16
  s_and_b32 s57, s17, 0xffff
  s_mov_b32 s58, 1792
  s_mov_b32 s59, 0x20000
  s_mov_b32 m0, 1408
  s_nop 0
  buffer_load_dwordx4 v105, s[56:59], 0 offen  lds
  s_mov_b32 m0, 1408
  s_nop 0
  buffer_load_dwordx4 v105, s[56:59], 0 offen offset:1024  lds
  s_mov_b32 s56, s34
  s_and_b32 s57, s35, 0xffff
  s_mov_b32 s58, 896
  s_mov_b32 s59, 0x20000
  s_mov_b32 m0, 3456
  s_nop 0
  buffer_load_dwordx4 v105, s[56:59], 0 offen  lds
  s_mov_b32 s52, s40
  s_and_b32 s53, s41, 0xffff
  s_mov_b32 s54, 8388608
  s_mov_b32 s55, 0x20000
  v_and_b32 v9, 1, v2
  v_lshlrev_b32 v9, 4, v9
  v_mov_b32 v10, 0xffff
  v_lshlrev_b32 v9, v9, v10
  v_bfe_u32 v10, v2, 1, 2
  v_cmp_eq_u32 vcc, 0, v10
  s_nop 1
  v_cndmask_b32 v16, 0, v9, vcc
  v_cmp_eq_u32 vcc, 1, v10
  s_nop 1
  v_cndmask_b32 v17, 0, v9, vcc
  v_cmp_eq_u32 vcc, 2, v10
  s_nop 1
  v_cndmask_b32 v18, 0, v9, vcc
  v_cmp_eq_u32 vcc, 3, v10
  s_nop 1
  v_cndmask_b32 v19, 0, v9, vcc
  v_mov_b32 v9, 0x0c0c0c0c
  s_mov_b32 s15, 0x01000100
  s_mov_b32 s69, 0x03020302
  v_bfi_b32 v88, v16, s15, v9
  v_bfi_b32 v92, v16, s69, v9
  v_bfi_b32 v89, v17, s15, v9
  v_bfi_b32 v93, v17, s69, v9
  v_bfi_b32 v90, v18, s15, v9
  v_bfi_b32 v94, v18, s69, v9
  v_bfi_b32 v91, v19, s15, v9
  v_bfi_b32 v95, v19, s69, v9
  s_mov_b32 s94, 0x0c0c0400
  s_mov_b32 s95, 0x04000c0c
  s_mov_b32 s100, 0xffffff00
  v_lshrrev_b32 v13, 1, v3
  v_lshlrev_b32 v13, 16, v13
  v_lshl_add_u32 v13, v2, 5, v13
  v_and_b32 v9, 1, v3
  v_lshl_add_u32 v13, v9, 4, v13
  s_lshl_b32 s14, s4, 13
  s_lshl_b32 s15, s60, 11
  s_add_u32 s14, s14, s15
  s_lshr_b32 s15, s5, 2
  s_lshl_b32 s15, s15, 8
  s_add_u32 s14, s14, s15
  s_add_u32 s14, s14, 32768
  s_waitcnt lgkmcnt(0)
  s_add_u32 s9, s42, 1
  s_and_b32 s43, s9, 0xff
  s_lshr_b32 s15, s9, 8
  s_add_u32 s15, s15, s9
  s_and_b32 s15, s15, 0xff
  s_lshl_b32 s15, s15, 8
  s_or_b32 s43, s43, s15
  s_lshr_b32 s15, s9, 16
  s_add_u32 s15, s15, s9
  s_and_b32 s15, s15, 0xff
  s_lshl_b32 s15, s15, 16
  s_or_b32 s43, s43, s15
  s_lshr_b32 s15, s9, 24
  s_add_u32 s15, s15, s9
  s_and_b32 s15, s15, 0xff
  s_lshl_b32 s15, s15, 24
  s_or_b32 s43, s43, s15
  v_mov_b32 v106, s43
  s_mov_b32 s96, 0x7060500
  s_mov_b32 s97, 0x7060501
  s_mov_b32 s98, 0x7060502
  s_mov_b32 s99, 0x7060503
  s_waitcnt vmcnt(17)
  v_perm_b32 v184, v168, v168, v88
  v_perm_b32 v185, v168, v168, v89
  v_perm_b32 v186, v168, v168, v90
  v_perm_b32 v187, v168, v168, v91
  v_perm_b32 v188, v168, v168, v92
  v_perm_b32 v189, v168, v168, v93
  v_perm_b32 v190, v168, v168, v94
  v_perm_b32 v191, v168, v168, v95
  v_perm_b32 v192, v169, v169, v88
  v_perm_b32 v193, v169, v169, v89
  v_perm_b32 v194, v169, v169, v90
  v_perm_b32 v195, v169, v169, v91
  v_perm_b32 v196, v169, v169, v92
  v_perm_b32 v197, v169, v169, v93
  v_perm_b32 v198, v169, v169, v94
  v_perm_b32 v199, v169, v169, v95
  v_perm_b32 v200, v170, v170, v88
  v_perm_b32 v201, v170, v170, v89
  v_perm_b32 v202, v170, v170, v90
  v_perm_b32 v203, v170, v170, v91
  v_perm_b32 v204, v170, v170, v92
  v_perm_b32 v205, v170, v170, v93
  v_perm_b32 v206, v170, v170, v94
  v_perm_b32 v207, v170, v170, v95
  v_perm_b32 v208, v171, v171, v88
  v_perm_b32 v209, v171, v171, v89
  v_perm_b32 v210, v171, v171, v90
  v_perm_b32 v211, v171, v171, v91
  v_perm_b32 v212, v171, v171, v92
  v_perm_b32 v213, v171, v171, v93
  v_perm_b32 v214, v171, v171, v94
  v_perm_b32 v215, v171, v171, v95
  v_perm_b32 v216, v172, v172, v88
  v_perm_b32 v217, v172, v172, v89
  v_perm_b32 v218, v172, v172, v90
  v_perm_b32 v219, v172, v172, v91
  v_perm_b32 v220, v172, v172, v92
  v_perm_b32 v221, v172, v172, v93
  v_perm_b32 v222, v172, v172, v94
  v_perm_b32 v223, v172, v172, v95
  v_perm_b32 v224, v173, v173, v88
  v_perm_b32 v225, v173, v173, v89
  v_perm_b32 v226, v173, v173, v90
  v_perm_b32 v227, v173, v173, v91
  v_perm_b32 v228, v173, v173, v92
  v_perm_b32 v229, v173, v173, v93
  v_perm_b32 v230, v173, v173, v94
  v_perm_b32 v231, v173, v173, v95
  v_perm_b32 v232, v174, v174, v88
  v_perm_b32 v233, v174, v174, v89
  v_perm_b32 v234, v174, v174, v90
  v_perm_b32 v235, v174, v174, v91
  v_perm_b32 v236, v174, v174, v92
  v_perm_b32 v237, v174, v174, v93
  v_perm_b32 v238, v174, v174, v94
  v_perm_b32 v239, v174, v174, v95
  v_perm_b32 v240, v175, v175, v88
  v_perm_b32 v241, v175, v175, v89
  v_perm_b32 v242, v175, v175, v90
  v_perm_b32 v243, v175, v175, v91
  v_perm_b32 v244, v175, v175, v92
  v_perm_b32 v245, v175, v175, v93
  v_perm_b32 v246, v175, v175, v94
  v_perm_b32 v247, v175, v175, v95
  v_perm_b32 v248, v176, v176, v88
  v_perm_b32 v249, v176, v176, v89
  v_perm_b32 v250, v176, v176, v90
  v_perm_b32 v251, v176, v176, v91
  v_perm_b32 v252, v176, v176, v92
  v_perm_b32 v253, v176, v176, v93
  v_perm_b32 v254, v176, v176, v94
  v_perm_b32 v255, v176, v176, v95
  v_perm_b32 v40, v177, v177, v88
  v_perm_b32 v41, v177, v177, v89
  v_perm_b32 v42, v177, v177, v90
  v_perm_b32 v43, v177, v177, v91
  v_perm_b32 v44, v177, v177, v92
  v_perm_b32 v45, v177, v177, v93
  v_perm_b32 v46, v177, v177, v94
  v_perm_b32 v47, v177, v177, v95
  v_perm_b32 v48, v178, v178, v88
  v_perm_b32 v49, v178, v178, v89
  v_perm_b32 v50, v178, v178, v90
  v_perm_b32 v51, v178, v178, v91
  v_perm_b32 v52, v178, v178, v92
  v_perm_b32 v53, v178, v178, v93
  v_perm_b32 v54, v178, v178, v94
  v_perm_b32 v55, v178, v178, v95
  v_perm_b32 v56, v179, v179, v88
  v_perm_b32 v57, v179, v179, v89
  v_perm_b32 v58, v179, v179, v90
  v_perm_b32 v59, v179, v179, v91
  v_perm_b32 v60, v179, v179, v92
  v_perm_b32 v61, v179, v179, v93
  v_perm_b32 v62, v179, v179, v94
  v_perm_b32 v63, v179, v179, v95
  v_perm_b32 v64, v180, v180, v88
  v_perm_b32 v65, v180, v180, v89
  v_perm_b32 v66, v180, v180, v90
  v_perm_b32 v67, v180, v180, v91
  v_perm_b32 v68, v180, v180, v92
  v_perm_b32 v69, v180, v180, v93
  v_perm_b32 v70, v180, v180, v94
  v_perm_b32 v71, v180, v180, v95
  v_perm_b32 v72, v181, v181, v88
  v_perm_b32 v73, v181, v181, v89
  v_perm_b32 v74, v181, v181, v90
  v_perm_b32 v75, v181, v181, v91
  v_perm_b32 v76, v181, v181, v92
  v_perm_b32 v77, v181, v181, v93
  v_perm_b32 v78, v181, v181, v94
  v_perm_b32 v79, v181, v181, v95
  s_waitcnt vmcnt(16)
  v_mfma_f32_16x16x32_bf16 v[20:23], v[184:187], v[112:115], 0
  v_mfma_f32_16x16x32_bf16 v[24:27], v[240:243], v[112:115], 0
  s_waitcnt vmcnt(15)
  v_mfma_f32_16x16x32_bf16 v[20:23], v[188:191], v[116:119], v[20:23]
  v_mfma_f32_16x16x32_bf16 v[24:27], v[244:247], v[116:119], v[24:27]
  s_waitcnt vmcnt(14)
  v_mfma_f32_16x16x32_bf16 v[20:23], v[192:195], v[120:123], v[20:23]
  v_mfma_f32_16x16x32_bf16 v[24:27], v[248:251], v[120:123], v[24:27]
  s_waitcnt vmcnt(13)
  v_mfma_f32_16x16x32_bf16 v[20:23], v[196:199], v[124:127], v[20:23]
  v_mfma_f32_16x16x32_bf16 v[24:27], v[252:255], v[124:127], v[24:27]
  s_waitcnt vmcnt(12)
  v_mfma_f32_16x16x32_bf16 v[20:23], v[200:203], v[128:131], v[20:23]
  v_mfma_f32_16x16x32_bf16 v[24:27], v[40:43], v[128:131], v[24:27]
  s_waitcnt vmcnt(11)
  v_mfma_f32_16x16x32_bf16 v[20:23], v[204:207], v[132:135], v[20:23]
  v_mfma_f32_16x16x32_bf16 v[24:27], v[44:47], v[132:135], v[24:27]
  s_waitcnt vmcnt(10)
  v_mfma_f32_16x16x32_bf16 v[20:23], v[208:211], v[136:139], v[20:23]
  v_mfma_f32_16x16x32_bf16 v[24:27], v[48:51], v[136:139], v[24:27]
  s_waitcnt vmcnt(9)
  v_mfma_f32_16x16x32_bf16 v[20:23], v[212:215], v[140:143], v[20:23]
  v_mfma_f32_16x16x32_bf16 v[24:27], v[52:55], v[140:143], v[24:27]
  s_waitcnt vmcnt(8)
  v_mfma_f32_16x16x32_bf16 v[20:23], v[216:219], v[144:147], v[20:23]
  v_mfma_f32_16x16x32_bf16 v[24:27], v[56:59], v[144:147], v[24:27]
  s_waitcnt vmcnt(7)
  v_mfma_f32_16x16x32_bf16 v[20:23], v[220:223], v[148:151], v[20:23]
  v_mfma_f32_16x16x32_bf16 v[24:27], v[60:63], v[148:151], v[24:27]
  s_waitcnt vmcnt(6)
  v_mfma_f32_16x16x32_bf16 v[20:23], v[224:227], v[152:155], v[20:23]
  v_mfma_f32_16x16x32_bf16 v[24:27], v[64:67], v[152:155], v[24:27]
  s_waitcnt vmcnt(5)
  v_mfma_f32_16x16x32_bf16 v[20:23], v[228:231], v[156:159], v[20:23]
  v_mfma_f32_16x16x32_bf16 v[24:27], v[68:71], v[156:159], v[24:27]
  s_waitcnt vmcnt(4)
  v_mfma_f32_16x16x32_bf16 v[20:23], v[232:235], v[160:163], v[20:23]
  v_mfma_f32_16x16x32_bf16 v[24:27], v[72:75], v[160:163], v[24:27]
  s_waitcnt vmcnt(3)
  v_mfma_f32_16x16x32_bf16 v[20:23], v[236:239], v[164:167], v[20:23]
  v_mfma_f32_16x16x32_bf16 v[24:27], v[76:79], v[164:167], v[24:27]
  s_nop 7
  v_add_f32_dpp v20, v24, v20 row_ror:8 row_mask:0xf bank_mask:0xf
  v_add_f32_dpp v21, v25, v21 row_ror:8 row_mask:0xf bank_mask:0xf
  v_add_f32_dpp v22, v26, v22 row_ror:8 row_mask:0xf bank_mask:0xf
  v_add_f32_dpp v23, v27, v23 row_ror:8 row_mask:0xf bank_mask:0xf
  v_perm_b32 v28, v20, v106, s96
  v_perm_b32 v29, v21, v106, s97
  v_perm_b32 v30, v22, v106, s98
  v_perm_b32 v31, v23, v106, s99
  s_mov_b32 exec_lo, 0x00ff00ff
  s_mov_b32 exec_hi, 0x00ff00ff
  buffer_store_dwordx4 v[28:31], v13, s[52:55], s14 offen sc1
  s_mov_b64 exec, -1
  s_mov_b32 s56, s28
  s_and_b32 s57, s29, 0xffff
  s_mov_b32 s58, 1605632
  s_mov_b32 s59, 0x20000
  s_mov_b32 s76, s30
  s_and_b32 s77, s31, 0xffff
  s_mov_b32 s78, 1605632
  s_mov_b32 s79, 0x20000
  s_cmp_ge_u32 s2, 224
  s_cselect_b32 s58, 0, s58
  s_cselect_b32 s78, 0, s78
  v_mul_u32_u24 v13, 50176, v3
  v_and_b32 v12, 7, v2
  v_lshl_add_u32 v13, v12, 4, v13
  s_mul_i32 s14, s4, 200704
  s_lshl_b32 s15, s5, 7
  s_add_u32 s14, s14, s15
  s_mov_b32 exec_lo, 0xff00ff
  s_mov_b32 exec_hi, 0xff00ff
  s_mov_b32 s15, s14
  buffer_load_dwordx4 a[0:3], v13, s[56:59], s15 offen offset:0 nt
  buffer_load_dwordx4 a[4:7], v13, s[56:59], s15 offen offset:3584 nt
  s_add_u32 s15, s15, 7168
  buffer_load_dwordx4 a[8:11], v13, s[56:59], s15 offen offset:0 nt
  buffer_load_dwordx4 a[12:15], v13, s[56:59], s15 offen offset:3584 nt
  s_add_u32 s15, s15, 7168
  buffer_load_dwordx4 a[16:19], v13, s[56:59], s15 offen offset:0 nt
  buffer_load_dwordx4 a[20:23], v13, s[56:59], s15 offen offset:3584 nt
  s_add_u32 s15, s15, 7168
  buffer_load_dwordx4 a[24:27], v13, s[56:59], s15 offen offset:0 nt
  buffer_load_dwordx4 a[28:31], v13, s[56:59], s15 offen offset:3584 nt
  s_add_u32 s15, s15, 7168
  buffer_load_dwordx4 a[32:35], v13, s[56:59], s15 offen offset:0 nt
  buffer_load_dwordx4 a[36:39], v13, s[56:59], s15 offen offset:3584 nt
  s_add_u32 s15, s15, 7168
  buffer_load_dwordx4 a[40:43], v13, s[56:59], s15 offen offset:0 nt
  buffer_load_dwordx4 a[44:47], v13, s[56:59], s15 offen offset:3584 nt
  s_add_u32 s15, s15, 7168
  buffer_load_dwordx4 a[48:51], v13, s[56:59], s15 offen offset:0 nt
  buffer_load_dwordx4 a[52:55], v13, s[56:59], s15 offen offset:3584 nt
  s_mov_b32 exec_lo, 0xff00ff00
  s_mov_b32 exec_hi, 0xff00ff00
  s_mov_b32 s15, s14
  buffer_load_dwordx4 a[0:3], v13, s[76:79], s15 offen offset:0 nt
  buffer_load_dwordx4 a[4:7], v13, s[76:79], s15 offen offset:3584 nt
  s_add_u32 s15, s15, 7168
  buffer_load_dwordx4 a[8:11], v13, s[76:79], s15 offen offset:0 nt
  buffer_load_dwordx4 a[12:15], v13, s[76:79], s15 offen offset:3584 nt
  s_add_u32 s15, s15, 7168
  buffer_load_dwordx4 a[16:19], v13, s[76:79], s15 offen offset:0 nt
  buffer_load_dwordx4 a[20:23], v13, s[76:79], s15 offen offset:3584 nt
  s_add_u32 s15, s15, 7168
  buffer_load_dwordx4 a[24:27], v13, s[76:79], s15 offen offset:0 nt
  buffer_load_dwordx4 a[28:31], v13, s[76:79], s15 offen offset:3584 nt
  s_add_u32 s15, s15, 7168
  buffer_load_dwordx4 a[32:35], v13, s[76:79], s15 offen offset:0 nt
  buffer_load_dwordx4 a[36:39], v13, s[76:79], s15 offen offset:3584 nt
  s_add_u32 s15, s15, 7168
  buffer_load_dwordx4 a[40:43], v13, s[76:79], s15 offen offset:0 nt
  buffer_load_dwordx4 a[44:47], v13, s[76:79], s15 offen offset:3584 nt
  s_add_u32 s15, s15, 7168
  buffer_load_dwordx4 a[48:51], v13, s[76:79], s15 offen offset:0 nt
  buffer_load_dwordx4 a[52:55], v13, s[76:79], s15 offen offset:3584 nt
  s_mov_b64 exec, -1
  s_lshl_b32 s14, s6, 13
  s_add_u32 s14, s14, 32768
  s_add_u32 s69, s14, 4096
  s_lshl_b32 s74, s2, 10
  s_add_u32 s74, s74, 163840
  s_mov_b32 s61, 3200000
L_w2:
  ds_read_b32 v9, v15 offset:1024
  s_waitcnt lgkmcnt(0)
  v_readfirstlane_b32 s15, v9
  s_nop 3
  s_cmp_ge_u32 s15, 1
  s_cbranch_scc1 L_w2_ok
  s_sleep 1
  s_sub_u32 s61, s61, 1
  s_cmp_lg_u32 s61, 0
  s_cbranch_scc1 L_w2
L_w2_ok:
  s_mov_b32 s61, 400000
L_qpoll:
  buffer_load_dwordx4 v[112:115], v105, s[52:55], s14 offen offset:0 sc1
  buffer_load_dwordx4 v[116:119], v105, s[52:55], s14 offen offset:1024 sc1
  buffer_load_dwordx4 v[120:123], v105, s[52:55], s14 offen offset:2048 sc1
  buffer_load_dwordx4 v[124:127], v105, s[52:55], s14 offen offset:3072 sc1
  buffer_load_dwordx4 v[128:131], v105, s[52:55], s69 offen offset:0 sc1
  buffer_load_dwordx4 v[132:135], v105, s[52:55], s69 offen offset:1024 sc1
  buffer_load_dwordx4 v[136:139], v105, s[52:55], s69 offen offset:2048 sc1
  buffer_load_dwordx4 v[140:143], v105, s[52:55], s69 offen offset:3072 sc1
  s_waitcnt vmcnt(0)
  v_perm_b32 v13, v113, v112, s94
  v_perm_b32 v11, v115, v114, s95
  v_bitop3_b32 v13, v13, v11, v106 bitop3:0x96
  v_perm_b32 v14, v117, v116, s94
  v_perm_b32 v11, v119, v118, s95
  v_bitop3_b32 v14, v14, v11, v106 bitop3:0x96
  v_or_b32 v13, v13, v14
  v_perm_b32 v14, v121, v120, s94
  v_perm_b32 v11, v123, v122, s95
  v_bitop3_b32 v14, v14, v11, v106 bitop3:0x96
  v_or_b32 v13, v13, v14
  v_perm_b32 v14, v125, v124, s94
  v_perm_b32 v11, v127, v126, s95
  v_bitop3_b32 v14, v14, v11, v106 bitop3:0x96
  v_or_b32 v13, v13, v14
  v_perm_b32 v14, v129, v128, s94
  v_perm_b32 v11, v131, v130, s95
  v_bitop3_b32 v14, v14, v11, v106 bitop3:0x96
  v_or_b32 v13, v13, v14
  v_perm_b32 v14, v133, v132, s94
  v_perm_b32 v11, v135, v134, s95
  v_bitop3_b32 v14, v14, v11, v106 bitop3:0x96
  v_or_b32 v13, v13, v14
  v_perm_b32 v14, v137, v136, s94
  v_perm_b32 v11, v139, v138, s95
  v_bitop3_b32 v14, v14, v11, v106 bitop3:0x96
  v_or_b32 v13, v13, v14
  v_perm_b32 v14, v141, v140, s94
  v_perm_b32 v11, v143, v142, s95
  v_bitop3_b32 v14, v14, v11, v106 bitop3:0x96
  v_or_b32 v13, v13, v14
  v_cmp_ne_u32 vcc, 0, v13
  s_cbranch_vccz L_qdone
  s_sub_u32 s61, s61, 1
  s_cmp_lg_u32 s61, 0
  s_cbranch_scc1 L_qpoll
L_qdone:
  v_and_b32 v112, s100, v112
  v_and_b32 v113, s100, v113
  v_and_b32 v114, s100, v114
  v_and_b32 v115, s100, v115
  v_and_b32 v116, s100, v116
  v_and_b32 v117, s100, v117
  v_and_b32 v118, s100, v118
  v_and_b32 v119, s100, v119
  v_and_b32 v120, s100, v120
  v_and_b32 v121, s100, v121
  v_and_b32 v122, s100, v122
  v_and_b32 v123, s100, v123
  v_and_b32 v124, s100, v124
  v_and_b32 v125, s100, v125
  v_and_b32 v126, s100, v126
  v_and_b32 v127, s100, v127
  v_and_b32 v128, s100, v128
  v_and_b32 v129, s100, v129
  v_and_b32 v130, s100, v130
  v_and_b32 v131, s100, v131
  v_and_b32 v132, s100, v132
  v_and_b32 v133, s100, v133
  v_and_b32 v134, s100, v134
  v_and_b32 v135, s100, v135
  v_and_b32 v136, s100, v136
  v_and_b32 v137, s100, v137
  v_and_b32 v138, s100, v138
  v_and_b32 v139, s100, v139
  v_and_b32 v140, s100, v140
  v_and_b32 v141, s100, v141
  v_and_b32 v142, s100, v142
  v_and_b32 v143, s100, v143
  v_add_f32 v112, v112, v120
  v_add_f32 v128, v128, v136
  v_add_f32 v113, v113, v121
  v_add_f32 v129, v129, v137
  v_add_f32 v114, v114, v122
  v_add_f32 v130, v130, v138
  v_add_f32 v115, v115, v123
  v_add_f32 v131, v131, v139
  v_add_f32 v116, v116, v124
  v_add_f32 v132, v132, v140
  v_add_f32 v117, v117, v125
  v_add_f32 v133, v133, v141
  v_add_f32 v118, v118, v126
  v_add_f32 v134, v134, v142
  v_add_f32 v119, v119, v127
  v_add_f32 v135, v135, v143
  v_add_f32 v112, v112, v128
  v_add_f32 v113, v113, v129
  v_add_f32 v114, v114, v130
  v_add_f32 v115, v115, v131
  v_add_f32 v116, v116, v132
  v_add_f32 v117, v117, v133
  v_add_f32 v118, v118, v134
  v_add_f32 v119, v119, v135
  v_cvt_pk_bf16_f32 v120, v112, v113
  v_cvt_pk_bf16_f32 v121, v114, v115
  v_cvt_pk_bf16_f32 v122, v116, v117
  v_cvt_pk_bf16_f32 v123, v118, v119
  v_lshlrev_b32 v9, 3, v1
  ds_write_b64 v9, v[120:121] offset:0
  ds_write_b64 v9, v[122:123] offset:512
  s_waitcnt lgkmcnt(0)
  s_barrier
  s_setprio 0
  v_lshrrev_b32 v10, 3, v2
  v_mul_u32_u24 v11, 896, v10
  v_mul_u32_u24 v13, 28, v3
  s_mul_i32 s15, s4, 112
  v_add3_u32 v13, v11, v13, s15
  ds_read_b32 v96, v13 offset:1408
  ds_read_b32 v97, v13 offset:1412
  ds_read_b32 v98, v13 offset:1416
  ds_read_b32 v99, v13 offset:1420
  ds_read_b32 v100, v13 offset:1424
  ds_read_b32 v101, v13 offset:1428
  ds_read_b32 v102, v13 offset:1432
  ds_read_b128 v[112:115], v105 offset:1408
  ds_read_b128 v[116:119], v105 offset:2304
  ds_read_b128 v[120:123], v105 offset:3456
  v_and_b32 v12, 7, v2
  v_lshlrev_b32 v14, 10, v12
  v_lshl_add_u32 v14, v10, 6, v14
  v_lshl_add_u32 v14, v3, 4, v14
  s_lshl_b32 s14, s5, 13
  s_lshl_b32 s15, s4, 7
  s_add_u32 s14, s14, s15
  s_add_u32 s14, s14, 163840
  s_waitcnt lgkmcnt(0)
  s_cmp_ge_u32 s2, 224
  s_cbranch_scc1 L_nos1
  v_perm_b32 v40, v96, v96, v88
  v_perm_b32 v41, v96, v96, v89
  v_perm_b32 v42, v96, v96, v90
  v_perm_b32 v43, v96, v96, v91
  v_perm_b32 v44, v96, v96, v92
  v_perm_b32 v45, v96, v96, v93
  v_perm_b32 v46, v96, v96, v94
  v_perm_b32 v47, v96, v96, v95
  v_perm_b32 v48, v97, v97, v88
  v_perm_b32 v49, v97, v97, v89
  v_perm_b32 v50, v97, v97, v90
  v_perm_b32 v51, v97, v97, v91
  v_perm_b32 v52, v97, v97, v92
  v_perm_b32 v53, v97, v97, v93
  v_perm_b32 v54, v97, v97, v94
  v_perm_b32 v55, v97, v97, v95
  v_perm_b32 v56, v98, v98, v88
  v_perm_b32 v57, v98, v98, v89
  v_perm_b32 v58, v98, v98, v90
  v_perm_b32 v59, v98, v98, v91
  v_perm_b32 v60, v98, v98, v92
  v_perm_b32 v61, v98, v98, v93
  v_perm_b32 v62, v98, v98, v94
  v_perm_b32 v63, v98, v98, v95
  v_perm_b32 v64, v99, v99, v88
  v_perm_b32 v65, v99, v99, v89
  v_perm_b32 v66, v99, v99, v90
  v_perm_b32 v67, v99, v99, v91
  v_perm_b32 v68, v99, v99, v92
  v_perm_b32 v69, v99, v99, v93
  v_perm_b32 v70, v99, v99, v94
  v_perm_b32 v71, v99, v99, v95
  v_perm_b32 v72, v100, v100, v88
  v_perm_b32 v73, v100, v100, v89
  v_perm_b32 v74, v100, v100, v90
  v_perm_b32 v75, v100, v100, v91
  v_perm_b32 v76, v100, v100, v92
  v_perm_b32 v77, v100, v100, v93
  v_perm_b32 v78, v100, v100, v94
  v_perm_b32 v79, v100, v100, v95
  v_perm_b32 v224, v101, v101, v88
  v_perm_b32 v225, v101, v101, v89
  v_perm_b32 v226, v101, v101, v90
  v_perm_b32 v227, v101, v101, v91
  v_perm_b32 v228, v101, v101, v92
  v_perm_b32 v229, v101, v101, v93
  v_perm_b32 v230, v101, v101, v94
  v_perm_b32 v231, v101, v101, v95
  v_perm_b32 v232, v102, v102, v88
  v_perm_b32 v233, v102, v102, v89
  v_perm_b32 v234, v102, v102, v90
  v_perm_b32 v235, v102, v102, v91
  v_perm_b32 v236, v102, v102, v92
  v_perm_b32 v237, v102, v102, v93
  v_perm_b32 v238, v102, v102, v94
  v_perm_b32 v239, v102, v102, v95
  v_mfma_f32_16x16x32_bf16 v[20:23], v[40:43], a[0:3], 0
  v_mfma_f32_16x16x32_bf16 v[20:23], v[44:47], a[4:7], v[20:23]
  v_mfma_f32_16x16x32_bf16 v[20:23], v[48:51], a[8:11], v[20:23]
  v_mfma_f32_16x16x32_bf16 v[20:23], v[52:55], a[12:15], v[20:23]
  v_mfma_f32_16x16x32_bf16 v[20:23], v[56:59], a[16:19], v[20:23]
  v_mfma_f32_16x16x32_bf16 v[20:23], v[60:63], a[20:23], v[20:23]
  v_mfma_f32_16x16x32_bf16 v[20:23], v[64:67], a[24:27], v[20:23]
  v_mfma_f32_16x16x32_bf16 v[20:23], v[68:71], a[28:31], v[20:23]
  v_mfma_f32_16x16x32_bf16 v[20:23], v[72:75], a[32:35], v[20:23]
  v_mfma_f32_16x16x32_bf16 v[20:23], v[76:79], a[36:39], v[20:23]
  v_mfma_f32_16x16x32_bf16 v[20:23], v[224:227], a[40:43], v[20:23]
  v_mfma_f32_16x16x32_bf16 v[20:23], v[228:231], a[44:47], v[20:23]
  v_mfma_f32_16x16x32_bf16 v[20:23], v[232:235], a[48:51], v[20:23]
  v_mfma_f32_16x16x32_bf16 v[20:23], v[236:239], a[52:55], v[20:23]
  s_nop 7
  v_perm_b32 v28, v20, v106, s96
  v_perm_b32 v29, v21, v106, s97
  v_perm_b32 v30, v22, v106, s98
  v_perm_b32 v31, v23, v106, s99
  buffer_store_dwordx4 v[28:31], v14, s[52:55], s14 offen sc1
L_nos1:
  v_lshlrev_b32 v128, 16, v112
  v_and_b32 v129, 0xffff0000, v112
  v_lshlrev_b32 v130, 16, v113
  v_and_b32 v131, 0xffff0000, v113
  v_lshlrev_b32 v132, 16, v114
  v_and_b32 v133, 0xffff0000, v114
  v_lshlrev_b32 v134, 16, v115
  v_and_b32 v135, 0xffff0000, v115
  v_lshlrev_b32 v136, 16, v116
  v_and_b32 v137, 0xffff0000, v116
  v_lshlrev_b32 v138, 16, v117
  v_and_b32 v139, 0xffff0000, v117
  v_lshlrev_b32 v140, 16, v118
  v_and_b32 v141, 0xffff0000, v118
  v_lshlrev_b32 v142, 16, v119
  v_and_b32 v143, 0xffff0000, v119
  v_lshlrev_b32 v144, 16, v120
  v_and_b32 v145, 0xffff0000, v120
  v_lshlrev_b32 v146, 16, v121
  v_and_b32 v147, 0xffff0000, v121
  v_lshlrev_b32 v148, 16, v122
  v_and_b32 v149, 0xffff0000, v122
  v_lshlrev_b32 v150, 16, v123
  v_and_b32 v151, 0xffff0000, v123
  v_mul_f32 v128, v128, v144
  v_mul_f32 v129, v129, v145
  v_mul_f32 v130, v130, v146
  v_mul_f32 v131, v131, v147
  v_mul_f32 v132, v132, v148
  v_mul_f32 v133, v133, v149
  v_mul_f32 v134, v134, v150
  v_mul_f32 v135, v135, v151
  v_mul_f32 v136, v136, v144
  v_mul_f32 v137, v137, v145
  v_mul_f32 v138, v138, v146
  v_mul_f32 v139, v139, v147
  v_mul_f32 v140, v140, v148
  v_mul_f32 v141, v141, v149
  v_mul_f32 v142, v142, v150
  v_mul_f32 v143, v143, v151
  v_cvt_pk_bf16_f32 v129, v128, v129
  v_cvt_pk_bf16_f32 v131, v130, v131
  v_cvt_pk_bf16_f32 v133, v132, v133
  v_cvt_pk_bf16_f32 v135, v134, v135
  v_cvt_pk_bf16_f32 v137, v136, v137
  v_cvt_pk_bf16_f32 v139, v138, v139
  v_cvt_pk_bf16_f32 v141, v140, v141
  v_cvt_pk_bf16_f32 v143, v142, v143
  v_lshlrev_b32 v128, 16, v129
  v_and_b32 v129, 0xffff0000, v129
  v_lshlrev_b32 v130, 16, v131
  v_and_b32 v131, 0xffff0000, v131
  v_lshlrev_b32 v132, 16, v133
  v_and_b32 v133, 0xffff0000, v133
  v_lshlrev_b32 v134, 16, v135
  v_and_b32 v135, 0xffff0000, v135
  v_lshlrev_b32 v136, 16, v137
  v_and_b32 v137, 0xffff0000, v137
  v_lshlrev_b32 v138, 16, v139
  v_and_b32 v139, 0xffff0000, v139
  v_lshlrev_b32 v140, 16, v141
  v_and_b32 v141, 0xffff0000, v141
  v_lshlrev_b32 v142, 16, v143
  v_and_b32 v143, 0xffff0000, v143
  v_add_f32 v128, v128, v132
  v_add_f32 v129, v129, v133
  v_add_f32 v130, v130, v134
  v_add_f32 v131, v131, v135
  v_add_f32 v136, v136, v140
  v_add_f32 v137, v137, v141
  v_add_f32 v138, v138, v142
  v_add_f32 v139, v139, v143
  v_add_f32 v128, v128, v130
  v_add_f32 v129, v129, v131
  v_add_f32 v136, v136, v138
  v_add_f32 v137, v137, v139
  v_add_f32 v128, v128, v129
  v_add_f32 v136, v136, v137
  s_nop 0
  v_add_f32_dpp v128, v128, v128 row_ror:8 row_mask:0xf bank_mask:0xf
  s_nop 0
  v_add_f32_dpp v136, v136, v136 row_ror:8 row_mask:0xf bank_mask:0xf
  s_nop 0
  v_add_f32_dpp v128, v128, v128 row_ror:4 row_mask:0xf bank_mask:0xf
  s_nop 0
  v_add_f32_dpp v136, v136, v136 row_ror:4 row_mask:0xf bank_mask:0xf
  s_nop 0
  v_add_f32_dpp v128, v128, v128 row_ror:2 row_mask:0xf bank_mask:0xf
  s_nop 0
  v_add_f32_dpp v136, v136, v136 row_ror:2 row_mask:0xf bank_mask:0xf
  s_nop 0
  v_add_f32_dpp v128, v128, v128 row_ror:1 row_mask:0xf bank_mask:0xf
  s_nop 0
  v_add_f32_dpp v136, v136, v136 row_ror:1 row_mask:0xf bank_mask:0xf
  v_mov_b32 v129, v128
  v_mov_b32 v137, v136
  s_nop 1
  v_permlane16_swap_b32 v128, v129
  v_permlane16_swap_b32 v136, v137
  v_add_f32 v128, v128, v129
  v_add_f32 v136, v136, v137
  v_mov_b32 v129, v128
  v_mov_b32 v137, v136
  s_nop 1
  v_permlane32_swap_b32 v128, v129
  v_permlane32_swap_b32 v136, v137
  v_add_f32 v128, v128, v129
  v_add_f32 v136, v136, v137
  v_cndmask_b32 v104, v128, v136, s[64:65]
  v_cvt_pk_bf16_f32 v104, v104, v104
  v_and_b32 v104, 0xffff0000, v104
  v_mul_f32 v104, 0xbfb8aa3b, v104
  v_exp_f32 v104, v104
  s_nop 0
  v_add_f32 v104, 1.0, v104
  v_rcp_f32 v104, v104
  s_nop 0
  v_cvt_pk_bf16_f32 v104, v104, v104
  v_and_b32 v104, 0xffff0000, v104
  v_mov_b32 v56, 0
  v_mov_b32 v57, 0
  v_mov_b32 v58, 0
  v_mov_b32 v59, 0
  v_mov_b32 v60, 0
  v_mov_b32 v61, 0
  v_mov_b32 v62, 0
  v_mov_b32 v63, 0
  v_mov_b32 v64, 0
  v_mov_b32 v65, 0
  v_mov_b32 v66, 0
  v_mov_b32 v67, 0
  v_mov_b32 v68, 0
  v_mov_b32 v69, 0
  v_mov_b32 v70, 0
  v_mov_b32 v71, 0
  s_cmp_ge_u32 s2, 224
  s_cbranch_scc1 L_noffn
  s_mov_b32 s61, 3200000
L_w3:
  ds_read_b32 v9, v15 offset:1028
  s_waitcnt lgkmcnt(0)
  v_readfirstlane_b32 s15, v9
  s_nop 3
  s_cmp_ge_u32 s15, 1
  s_cbranch_scc1 L_w3_ok
  s_sleep 4
  s_sub_u32 s61, s61, 1
  s_cmp_lg_u32 s61, 0
  s_cbranch_scc1 L_w3
L_w3_ok:
  s_mov_b32 s61, 400000
L_hpoll:
  buffer_load_dwordx4 v[20:23], v105, s[52:55], s74 offen sc1
  s_waitcnt vmcnt(0)
  v_perm_b32 v13, v21, v20, s94
  v_perm_b32 v11, v23, v22, s95
  v_bitop3_b32 v13, v13, v11, v106 bitop3:0x96
  v_cmp_ne_u32 vcc, 0, v13
  s_cbranch_vccz L_hdone
  s_sleep 32
  s_sub_u32 s61, s61, 1
  s_cmp_lg_u32 s61, 0
  s_cbranch_scc1 L_hpoll
L_hdone:
  v_and_b32 v20, s100, v20
  v_and_b32 v21, s100, v21
  v_and_b32 v22, s100, v22
  v_and_b32 v23, s100, v23
  v_add_f32_dpp v20, v20, v20 row_ror:8 row_mask:0xf bank_mask:0xf
  v_add_f32_dpp v21, v21, v21 row_ror:8 row_mask:0xf bank_mask:0xf
  v_add_f32_dpp v22, v22, v22 row_ror:8 row_mask:0xf bank_mask:0xf
  v_add_f32_dpp v23, v23, v23 row_ror:8 row_mask:0xf bank_mask:0xf
  v_mov_b32 v24, v20
  v_mov_b32 v25, v21
  v_mov_b32 v26, v22
  v_mov_b32 v27, v23
  v_permlane16_swap_b32 v20, v24
  v_permlane16_swap_b32 v21, v25
  v_permlane16_swap_b32 v22, v26
  v_permlane16_swap_b32 v23, v27
  v_add_f32 v20, v20, v24
  v_add_f32 v21, v21, v25
  v_add_f32 v22, v22, v26
  v_add_f32 v23, v23, v27
  v_mov_b32 v24, v20
  v_mov_b32 v25, v21
  v_mov_b32 v26, v22
  v_mov_b32 v27, v23
  v_permlane32_swap_b32 v20, v24
  v_permlane32_swap_b32 v21, v25
  v_permlane32_swap_b32 v22, v26
  v_permlane32_swap_b32 v23, v27
  v_add_f32 v20, v20, v24
  v_add_f32 v21, v21, v25
  v_add_f32 v22, v22, v26
  v_add_f32 v23, v23, v27
  v_cvt_pk_bf16_f32 v9, v20, v21
  v_cvt_pk_bf16_f32 v10, v22, v23
  v_lshlrev_b32 v20, 16, v9
  v_and_b32 v21, 0xffff0000, v9
  v_lshlrev_b32 v22, 16, v10
  v_and_b32 v23, 0xffff0000, v10
  s_nop 1
  v_mov_b32_dpp v24, v20 row_ror:4 row_mask:0xf bank_mask:0xf
  v_mov_b32_dpp v25, v21 row_ror:4 row_mask:0xf bank_mask:0xf
  v_mov_b32_dpp v26, v22 row_ror:4 row_mask:0xf bank_mask:0xf
  v_mov_b32_dpp v27, v23 row_ror:4 row_mask:0xf bank_mask:0xf
  v_mul_f32 v28, 0xbfb8aa3b, v20
  v_mul_f32 v29, 0xbfb8aa3b, v21
  v_mul_f32 v30, 0xbfb8aa3b, v22
  v_mul_f32 v31, 0xbfb8aa3b, v23
  v_exp_f32 v28, v28
  v_exp_f32 v29, v29
  v_exp_f32 v30, v30
  v_exp_f32 v31, v31
  s_nop 0
  v_add_f32 v28, 1.0, v28
  v_add_f32 v29, 1.0, v29
  v_add_f32 v30, 1.0, v30
  v_add_f32 v31, 1.0, v31
  v_rcp_f32 v28, v28
  v_rcp_f32 v29, v29
  v_rcp_f32 v30, v30
  v_rcp_f32 v31, v31
  s_nop 0
  v_mul_f32 v20, v20, v28
  v_mul_f32 v21, v21, v29
  v_mul_f32 v22, v22, v30
  v_mul_f32 v23, v23, v31
  v_cvt_pk_bf16_f32 v9, v20, v21
  v_cvt_pk_bf16_f32 v10, v22, v23
  v_lshlrev_b32 v20, 16, v9
  v_and_b32 v21, 0xffff0000, v9
  v_lshlrev_b32 v22, 16, v10
  v_and_b32 v23, 0xffff0000, v10
  v_mul_f32 v20, v20, v24
  v_mul_f32 v21, v21, v25
  v_mul_f32 v22, v22, v26
  v_mul_f32 v23, v23, v27
  v_cvt_pk_bf16_f32 v28, v20, v21
  v_cvt_pk_bf16_f32 v29, v22, v23
  v_lshlrev_b32 v9, 3, v1
  s_mov_b64 exec, 15
  ds_write_b64 v9, v[28:29] offset:1152
  s_mov_b64 exec, -1
  v_lshrrev_b32 v9, 3, v2
  v_lshlrev_b32 v9, 4, v9
  v_lshl_add_u32 v9, v3, 2, v9
  s_waitcnt lgkmcnt(0)
  ds_read_b32 v168, v9 offset:1152
  s_waitcnt lgkmcnt(0)
  v_perm_b32 v96, v168, v168, v88
  v_perm_b32 v97, v168, v168, v89
  v_perm_b32 v98, v168, v168, v90
  v_perm_b32 v99, v168, v168, v91
  v_perm_b32 v100, v168, v168, v92
  v_perm_b32 v101, v168, v168, v93
  v_perm_b32 v102, v168, v168, v94
  v_perm_b32 v103, v168, v168, v95
L_noffn:
  s_mov_b32 s76, s32
  s_and_b32 s77, s33, 0xffff
  s_mov_b32 s78, 1605632
  s_mov_b32 s79, 0x20000
  v_mul_u32_u24 v93, 1792, v3
  v_lshl_add_u32 v93, v2, 4, v93
  s_mul_i32 s73, s2, 7168
  s_mov_b32 s56, s24
  s_and_b32 s57, s25, 0xffff
  s_mov_b32 s58, 3670016
  s_mov_b32 s59, 0x20000
  v_mul_u32_u24 v9, 7168, v3
  v_lshl_add_u32 v9, v2, 4, v9
  s_lshl_b32 s14, s4, 9
  s_lshr_b32 s15, s5, 3
  s_lshl_b32 s15, s15, 7
  s_add_u32 s14, s14, s15
  s_and_b32 s15, s5, 3
  s_lshl_b32 s15, s15, 5
  s_add_u32 s14, s14, s15
  s_and_b32 s15, s5, 4
  s_add_u32 s14, s14, s15
  s_mul_i32 s14, s14, 896
  v_mov_b32 v92, v9
  v_lshrrev_b32 v9, 3, v2
  v_lshlrev_b32 v9, 4, v9
  v_and_b32 v10, 7, v2
  v_add_u32 v9, v9, v10
  v_lshlrev_b32 v88, 6, v9
  v_lshl_add_u32 v88, v3, 4, v88
  s_lshl_b32 s70, s4, 5
  s_add_u32 s70, s70, s5
  s_lshl_b32 s72, s70, 5
  s_add_u32 s72, s72, 1048576
  s_lshl_b32 s70, s70, 11
  s_add_u32 s70, s70, 2097152
  v_lshrrev_b32 v90, 1, v3
  v_lshlrev_b32 v90, 6, v90
  v_and_b32 v10, 1, v3
  v_lshl_add_u32 v90, v10, 3, v90
  v_lshrrev_b32 v10, 1, v2
  v_add_u32 v90, v90, v10
  v_lshlrev_b32 v90, 13, v90
  v_and_b32 v10, 1, v2
  v_lshl_add_u32 v90, v10, 4, v90
  s_waitcnt vmcnt(0)
  v_mov_b32 v89, s9
  s_lshl_b32 s27, s2, 7
  s_add_u32 s27, s27, 393216
  s_mov_b32 s26, 393216
  s_mov_b32 s24, 9
  s_mov_b32 s61, 3200000
L_w4:
  ds_read_b32 v9, v15 offset:1032
  s_waitcnt lgkmcnt(0)
  v_readfirstlane_b32 s15, v9
  s_nop 3
  s_cmp_ge_u32 s15, 8
  s_cbranch_scc1 L_w4_ok
  s_sleep 2
  s_sub_u32 s61, s61, 1
  s_cmp_lg_u32 s61, 0
  s_cbranch_scc1 L_w4
L_w4_ok:
  s_mov_b32 s60, s2
  s_add_u32 s60, s60, s24
  s_and_b32 s15, s60, 0xff
  s_lshl_b32 s15, s15, 7
  s_add_u32 s15, s15, s26
  s_load_dword s44, s[40:41], s15 glc
  s_add_u32 s60, s60, s24
  s_and_b32 s15, s60, 0xff
  s_lshl_b32 s15, s15, 7
  s_add_u32 s15, s15, s26
  s_load_dword s45, s[40:41], s15 glc
  s_add_u32 s60, s60, s24
  s_and_b32 s15, s60, 0xff
  s_lshl_b32 s15, s15, 7
  s_add_u32 s15, s15, s26
  s_load_dword s46, s[40:41], s15 glc
  s_add_u32 s60, s60, s24
  s_and_b32 s15, s60, 0xff
  s_lshl_b32 s15, s15, 7
  s_add_u32 s15, s15, s26
  s_load_dword s47, s[40:41], s15 glc
  s_add_u32 s60, s60, s24
  s_and_b32 s15, s60, 0xff
  s_lshl_b32 s15, s15, 7
  s_add_u32 s15, s15, s26
  s_load_dword s48, s[40:41], s15 glc
  s_add_u32 s60, s60, s24
  s_and_b32 s15, s60, 0xff
  s_lshl_b32 s15, s15, 7
  s_add_u32 s15, s15, s26
  s_load_dword s49, s[40:41], s15 glc
  s_add_u32 s60, s60, s24
  s_and_b32 s15, s60, 0xff
  s_lshl_b32 s15, s15, 7
  s_add_u32 s15, s15, s26
  s_load_dword s50, s[40:41], s15 glc
  s_add_u32 s60, s60, s24
  s_and_b32 s15, s60, 0xff
  s_lshl_b32 s15, s15, 7
  s_add_u32 s15, s15, s26
  s_load_dword s51, s[40:41], s15 glc
  s_add_u32 s60, s60, s24
  s_and_b32 s15, s60, 0xff
  s_lshl_b32 s15, s15, 7
  s_add_u32 s15, s15, s26
  s_load_dword s16, s[40:41], s15 glc
  s_add_u32 s60, s60, s24
  s_and_b32 s15, s60, 0xff
  s_lshl_b32 s15, s15, 7
  s_add_u32 s15, s15, s26
  s_load_dword s17, s[40:41], s15 glc
  s_add_u32 s60, s60, s24
  s_and_b32 s15, s60, 0xff
  s_lshl_b32 s15, s15, 7
  s_add_u32 s15, s15, s26
  s_load_dword s18, s[40:41], s15 glc
  s_add_u32 s60, s60, s24
  s_and_b32 s15, s60, 0xff
  s_lshl_b32 s15, s15, 7
  s_add_u32 s15, s15, s26
  s_load_dword s19, s[40:41], s15 glc
  s_add_u32 s60, s60, s24
  s_and_b32 s15, s60, 0xff
  s_lshl_b32 s15, s15, 7
  s_add_u32 s15, s15, s26
  s_load_dword s20, s[40:41], s15 glc
  s_add_u32 s60, s60, s24
  s_and_b32 s15, s60, 0xff
  s_lshl_b32 s15, s15, 7
  s_add_u32 s15, s15, s26
  s_load_dword s21, s[40:41], s15 glc
  s_add_u32 s60, s60, s24
  s_and_b32 s15, s60, 0xff
  s_lshl_b32 s15, s15, 7
  s_add_u32 s15, s15, s26
  s_load_dword s22, s[40:41], s15 glc
  s_add_u32 s60, s60, s24
  s_and_b32 s15, s60, 0xff
  s_lshl_b32 s15, s15, 7
  s_add_u32 s15, s15, s26
  s_load_dword s23, s[40:41], s15 glc
  s_add_u32 s24, s24, 24
  s_mov_b64 exec, 1
  buffer_store_dword v89, off, s[52:55], s27 sc1
  s_mov_b64 exec, -1
  s_waitcnt lgkmcnt(0)
  s_mov_b32 s60, 0
  s_cmp_eq_u32 s44, s9
  s_addc_u32 s60, s60, 0
  s_cmp_eq_u32 s45, s9
  s_addc_u32 s60, s60, 0
  s_cmp_eq_u32 s46, s9
  s_addc_u32 s60, s60, 0
  s_cmp_eq_u32 s47, s9
  s_addc_u32 s60, s60, 0
  s_cmp_eq_u32 s48, s9
  s_addc_u32 s60, s60, 0
  s_cmp_eq_u32 s49, s9
  s_addc_u32 s60, s60, 0
  s_cmp_eq_u32 s50, s9
  s_addc_u32 s60, s60, 0
  s_cmp_eq_u32 s51, s9
  s_addc_u32 s60, s60, 0
  s_cmp_eq_u32 s16, s9
  s_addc_u32 s60, s60, 0
  s_cmp_eq_u32 s17, s9
  s_addc_u32 s60, s60, 0
  s_cmp_eq_u32 s18, s9
  s_addc_u32 s60, s60, 0
  s_cmp_eq_u32 s19, s9
  s_addc_u32 s60, s60, 0
  s_cmp_eq_u32 s20, s9
  s_addc_u32 s60, s60, 0
  s_cmp_eq_u32 s21, s9
  s_addc_u32 s60, s60, 0
  s_cmp_eq_u32 s22, s9
  s_addc_u32 s60, s60, 0
  s_cmp_eq_u32 s23, s9
  s_addc_u32 s60, s60, 0
  s_add_u32 s26, s26, 32768
  s_add_u32 s27, s27, 32768
  s_mov_b32 s69, 0
  s_cmp_ge_u32 s60, 3
  s_addc_u32 s69, s69, 0
  s_cmp_ge_u32 s60, 10
  s_addc_u32 s69, s69, 0
  s_cmp_ge_u32 s60, 14
  s_addc_u32 s69, s69, 0
  v_mov_b32 v9, s69
  ds_write_b32 v15, v9 offset:1036
  s_mov_b32 s61, 3200000
L_w5:
  ds_read_b32 v9, v15 offset:1032
  s_waitcnt lgkmcnt(0)
  v_readfirstlane_b32 s15, v9
  s_nop 3
  s_cmp_ge_u32 s15, 22
  s_cbranch_scc1 L_w5_ok
  s_sleep 2
  s_sub_u32 s61, s61, 1
  s_cmp_lg_u32 s61, 0
  s_cbranch_scc1 L_w5
L_w5_ok:
  s_mov_b32 s60, s2
  s_add_u32 s60, s60, s24
  s_and_b32 s15, s60, 0xff
  s_lshl_b32 s15, s15, 7
  s_add_u32 s15, s15, s26
  s_load_dword s44, s[40:41], s15 glc
  s_add_u32 s60, s60, s24
  s_and_b32 s15, s60, 0xff
  s_lshl_b32 s15, s15, 7
  s_add_u32 s15, s15, s26
  s_load_dword s45, s[40:41], s15 glc
  s_add_u32 s60, s60, s24
  s_and_b32 s15, s60, 0xff
  s_lshl_b32 s15, s15, 7
  s_add_u32 s15, s15, s26
  s_load_dword s46, s[40:41], s15 glc
  s_add_u32 s60, s60, s24
  s_and_b32 s15, s60, 0xff
  s_lshl_b32 s15, s15, 7
  s_add_u32 s15, s15, s26
  s_load_dword s47, s[40:41], s15 glc
  s_add_u32 s60, s60, s24
  s_and_b32 s15, s60, 0xff
  s_lshl_b32 s15, s15, 7
  s_add_u32 s15, s15, s26
  s_load_dword s48, s[40:41], s15 glc
  s_add_u32 s60, s60, s24
  s_and_b32 s15, s60, 0xff
  s_lshl_b32 s15, s15, 7
  s_add_u32 s15, s15, s26
  s_load_dword s49, s[40:41], s15 glc
  s_add_u32 s60, s60, s24
  s_and_b32 s15, s60, 0xff
  s_lshl_b32 s15, s15, 7
  s_add_u32 s15, s15, s26
  s_load_dword s50, s[40:41], s15 glc
  s_add_u32 s60, s60, s24
  s_and_b32 s15, s60, 0xff
  s_lshl_b32 s15, s15, 7
  s_add_u32 s15, s15, s26
  s_load_dword s51, s[40:41], s15 glc
  s_add_u32 s60, s60, s24
  s_and_b32 s15, s60, 0xff
  s_lshl_b32 s15, s15, 7
  s_add_u32 s15, s15, s26
  s_load_dword s16, s[40:41], s15 glc
  s_add_u32 s60, s60, s24
  s_and_b32 s15, s60, 0xff
  s_lshl_b32 s15, s15, 7
  s_add_u32 s15, s15, s26
  s_load_dword s17, s[40:41], s15 glc
  s_add_u32 s60, s60, s24
  s_and_b32 s15, s60, 0xff
  s_lshl_b32 s15, s15, 7
  s_add_u32 s15, s15, s26
  s_load_dword s18, s[40:41], s15 glc
  s_add_u32 s60, s60, s24
  s_and_b32 s15, s60, 0xff
  s_lshl_b32 s15, s15, 7
  s_add_u32 s15, s15, s26
  s_load_dword s19, s[40:41], s15 glc
  s_add_u32 s60, s60, s24
  s_and_b32 s15, s60, 0xff
  s_lshl_b32 s15, s15, 7
  s_add_u32 s15, s15, s26
  s_load_dword s20, s[40:41], s15 glc
  s_add_u32 s60, s60, s24
  s_and_b32 s15, s60, 0xff
  s_lshl_b32 s15, s15, 7
  s_add_u32 s15, s15, s26
  s_load_dword s21, s[40:41], s15 glc
  s_add_u32 s60, s60, s24
  s_and_b32 s15, s60, 0xff
  s_lshl_b32 s15, s15, 7
  s_add_u32 s15, s15, s26
  s_load_dword s22, s[40:41], s15 glc
  s_add_u32 s60, s60, s24
  s_and_b32 s15, s60, 0xff
  s_lshl_b32 s15, s15, 7
  s_add_u32 s15, s15, s26
  s_load_dword s23, s[40:41], s15 glc
  s_add_u32 s24, s24, 24
  s_mov_b64 exec, 1
  buffer_store_dword v89, off, s[52:55], s27 sc1
  s_mov_b64 exec, -1
  s_waitcnt lgkmcnt(0)
  s_mov_b32 s60, 0
  s_cmp_eq_u32 s44, s9
  s_addc_u32 s60, s60, 0
  s_cmp_eq_u32 s45, s9
  s_addc_u32 s60, s60, 0
  s_cmp_eq_u32 s46, s9
  s_addc_u32 s60, s60, 0
  s_cmp_eq_u32 s47, s9
  s_addc_u32 s60, s60, 0
  s_cmp_eq_u32 s48, s9
  s_addc_u32 s60, s60, 0
  s_cmp_eq_u32 s49, s9
  s_addc_u32 s60, s60, 0
  s_cmp_eq_u32 s50, s9
  s_addc_u32 s60, s60, 0
  s_cmp_eq_u32 s51, s9
  s_addc_u32 s60, s60, 0
  s_cmp_eq_u32 s16, s9
  s_addc_u32 s60, s60, 0
  s_cmp_eq_u32 s17, s9
  s_addc_u32 s60, s60, 0
  s_cmp_eq_u32 s18, s9
  s_addc_u32 s60, s60, 0
  s_cmp_eq_u32 s19, s9
  s_addc_u32 s60, s60, 0
  s_cmp_eq_u32 s20, s9
  s_addc_u32 s60, s60, 0
  s_cmp_eq_u32 s21, s9
  s_addc_u32 s60, s60, 0
  s_cmp_eq_u32 s22, s9
  s_addc_u32 s60, s60, 0
  s_cmp_eq_u32 s23, s9
  s_addc_u32 s60, s60, 0
  s_add_u32 s26, s26, 32768
  s_add_u32 s27, s27, 32768
  s_mov_b32 s69, 0
  s_cmp_ge_u32 s60, 3
  s_addc_u32 s69, s69, 0
  s_cmp_ge_u32 s60, 10
  s_addc_u32 s69, s69, 0
  s_cmp_ge_u32 s60, 14
  s_addc_u32 s69, s69, 0
  v_mov_b32 v9, s69
  ds_write_b32 v15, v9 offset:1036
  s_mov_b32 s61, 3200000
L_w6:
  ds_read_b32 v9, v15 offset:1032
  s_waitcnt lgkmcnt(0)
  v_readfirstlane_b32 s15, v9
  s_nop 3
  s_cmp_ge_u32 s15, 28
  s_cbranch_scc1 L_w6_ok
  s_sleep 2
  s_sub_u32 s61, s61, 1
  s_cmp_lg_u32 s61, 0
  s_cbranch_scc1 L_w6
L_w6_ok:
  v_and_b32 v9, 4, v1
  ds_read_b32 v28, v9 offset:1056
  ds_read_b128 v[112:115], v105 offset:4608
  ds_read_b128 v[116:119], v105 offset:5632
  ds_read_b128 v[120:123], v105 offset:6656
  ds_read_b128 v[124:127], v105 offset:7680
  ds_read_b128 v[128:131], v105 offset:8704
  ds_read_b128 v[132:135], v105 offset:9728
  ds_read_b128 v[136:139], v105 offset:10752
  ds_read_b128 v[140:143], v105 offset:11776
  ds_read_b128 v[144:147], v105 offset:12800
  ds_read_b128 v[148:151], v105 offset:13824
  ds_read_b128 v[152:155], v105 offset:14848
  ds_read_b128 v[156:159], v105 offset:15872
  ds_read_b128 v[160:163], v105 offset:16896
  ds_read_b128 v[164:167], v105 offset:17920
  ds_read_b128 v[168:171], v105 offset:18944
  ds_read_b128 v[172:175], v105 offset:19968
  v_mov_b32 v29, s9
  v_mov_b32 v31, s9
  v_lshlrev_b32 v14, 2, v9
  s_lshl_b32 s69, s6, 9
  s_add_u32 s69, s69, 8192
  s_lshl_b32 s60, s7, 5
  s_add_u32 s60, s60, s69
  s_mov_b32 s71, s69
  s_waitcnt lgkmcnt(0)
  v_mul_f32 v10, s10, v28
  v_fma_f32 v112, v112, s10, -v10
  v_fma_f32 v113, v113, s10, -v10
  v_fma_f32 v114, v114, s10, -v10
  v_fma_f32 v115, v115, s10, -v10
  v_fma_f32 v116, v116, s10, -v10
  v_fma_f32 v117, v117, s10, -v10
  v_fma_f32 v118, v118, s10, -v10
  v_fma_f32 v119, v119, s10, -v10
  v_fma_f32 v120, v120, s10, -v10
  v_fma_f32 v121, v121, s10, -v10
  v_fma_f32 v122, v122, s10, -v10
  v_fma_f32 v123, v123, s10, -v10
  v_fma_f32 v124, v124, s10, -v10
  v_fma_f32 v125, v125, s10, -v10
  v_fma_f32 v126, v126, s10, -v10
  v_fma_f32 v127, v127, s10, -v10
  v_fma_f32 v128, v128, s10, -v10
  v_fma_f32 v129, v129, s10, -v10
  v_fma_f32 v130, v130, s10, -v10
  v_fma_f32 v131, v131, s10, -v10
  v_fma_f32 v132, v132, s10, -v10
  v_fma_f32 v133, v133, s10, -v10
  v_fma_f32 v134, v134, s10, -v10
  v_fma_f32 v135, v135, s10, -v10
  v_fma_f32 v136, v136, s10, -v10
  v_fma_f32 v137, v137, s10, -v10
  v_fma_f32 v138, v138, s10, -v10
  v_fma_f32 v139, v139, s10, -v10
  v_fma_f32 v140, v140, s10, -v10
  v_fma_f32 v141, v141, s10, -v10
  v_fma_f32 v142, v142, s10, -v10
  v_fma_f32 v143, v143, s10, -v10
  v_fma_f32 v144, v144, s10, -v10
  v_fma_f32 v145, v145, s10, -v10
  v_fma_f32 v146, v146, s10, -v10
  v_fma_f32 v147, v147, s10, -v10
  v_fma_f32 v148, v148, s10, -v10
  v_fma_f32 v149, v149, s10, -v10
  v_fma_f32 v150, v150, s10, -v10
  v_fma_f32 v151, v151, s10, -v10
  v_fma_f32 v152, v152, s10, -v10
  v_fma_f32 v153, v153, s10, -v10
  v_fma_f32 v154, v154, s10, -v10
  v_fma_f32 v155, v155, s10, -v10
  v_fma_f32 v156, v156, s10, -v10
  v_fma_f32 v157, v157, s10, -v10
  v_fma_f32 v158, v158, s10, -v10
  v_fma_f32 v159, v159, s10, -v10
  v_fma_f32 v160, v160, s10, -v10
  v_fma_f32 v161, v161, s10, -v10
  v_fma_f32 v162, v162, s10, -v10
  v_fma_f32 v163, v163, s10, -v10
  v_fma_f32 v164, v164, s10, -v10
  v_fma_f32 v165, v165, s10, -v10
  v_fma_f32 v166, v166, s10, -v10
  v_fma_f32 v167, v167, s10, -v10
  v_fma_f32 v168, v168, s10, -v10
  v_fma_f32 v169, v169, s10, -v10
  v_fma_f32 v170, v170, s10, -v10
  v_fma_f32 v171, v171, s10, -v10
  v_fma_f32 v172, v172, s10, -v10
  v_fma_f32 v173, v173, s10, -v10
  v_fma_f32 v174, v174, s10, -v10
  v_fma_f32 v175, v175, s10, -v10
  v_exp_f32 v112, v112
  v_exp_f32 v113, v113
  v_exp_f32 v114, v114
  v_exp_f32 v115, v115
  v_exp_f32 v116, v116
  v_exp_f32 v117, v117
  v_exp_f32 v118, v118
  v_exp_f32 v119, v119
  v_exp_f32 v120, v120
  v_exp_f32 v121, v121
  v_exp_f32 v122, v122
  v_exp_f32 v123, v123
  v_exp_f32 v124, v124
  v_exp_f32 v125, v125
  v_exp_f32 v126, v126
  v_exp_f32 v127, v127
  v_exp_f32 v128, v128
  v_exp_f32 v129, v129
  v_exp_f32 v130, v130
  v_exp_f32 v131, v131
  v_exp_f32 v132, v132
  v_exp_f32 v133, v133
  v_exp_f32 v134, v134
  v_exp_f32 v135, v135
  v_exp_f32 v136, v136
  v_exp_f32 v137, v137
  v_exp_f32 v138, v138
  v_exp_f32 v139, v139
  v_exp_f32 v140, v140
  v_exp_f32 v141, v141
  v_exp_f32 v142, v142
  v_exp_f32 v143, v143
  v_exp_f32 v144, v144
  v_exp_f32 v145, v145
  v_exp_f32 v146, v146
  v_exp_f32 v147, v147
  v_exp_f32 v148, v148
  v_exp_f32 v149, v149
  v_exp_f32 v150, v150
  v_exp_f32 v151, v151
  v_exp_f32 v152, v152
  v_exp_f32 v153, v153
  v_exp_f32 v154, v154
  v_exp_f32 v155, v155
  v_exp_f32 v156, v156
  v_exp_f32 v157, v157
  v_exp_f32 v158, v158
  v_exp_f32 v159, v159
  v_exp_f32 v160, v160
  v_exp_f32 v161, v161
  v_exp_f32 v162, v162
  v_exp_f32 v163, v163
  v_exp_f32 v164, v164
  v_exp_f32 v165, v165
  v_exp_f32 v166, v166
  v_exp_f32 v167, v167
  v_exp_f32 v168, v168
  v_exp_f32 v169, v169
  v_exp_f32 v170, v170
  v_exp_f32 v171, v171
  v_exp_f32 v172, v172
  v_exp_f32 v173, v173
  v_exp_f32 v174, v174
  v_exp_f32 v175, v175
  v_add_f32 v112, v112, v144
  v_add_f32 v113, v113, v145
  v_add_f32 v114, v114, v146
  v_add_f32 v115, v115, v147
  v_add_f32 v116, v116, v148
  v_add_f32 v117, v117, v149
  v_add_f32 v118, v118, v150
  v_add_f32 v119, v119, v151
  v_add_f32 v120, v120, v152
  v_add_f32 v121, v121, v153
  v_add_f32 v122, v122, v154
  v_add_f32 v123, v123, v155
  v_add_f32 v124, v124, v156
  v_add_f32 v125, v125, v157
  v_add_f32 v126, v126, v158
  v_add_f32 v127, v127, v159
  v_add_f32 v128, v128, v160
  v_add_f32 v129, v129, v161
  v_add_f32 v130, v130, v162
  v_add_f32 v131, v131, v163
  v_add_f32 v132, v132, v164
  v_add_f32 v133, v133, v165
  v_add_f32 v134, v134, v166
  v_add_f32 v135, v135, v167
  v_add_f32 v136, v136, v168
  v_add_f32 v137, v137, v169
  v_add_f32 v138, v138, v170
  v_add_f32 v139, v139, v171
  v_add_f32 v140, v140, v172
  v_add_f32 v141, v141, v173
  v_add_f32 v142, v142, v174
  v_add_f32 v143, v143, v175
  v_add_f32 v112, v112, v128
  v_add_f32 v113, v113, v129
  v_add_f32 v114, v114, v130
  v_add_f32 v115, v115, v131
  v_add_f32 v116, v116, v132
  v_add_f32 v117, v117, v133
  v_add_f32 v118, v118, v134
  v_add_f32 v119, v119, v135
  v_add_f32 v120, v120, v136
  v_add_f32 v121, v121, v137
  v_add_f32 v122, v122, v138
  v_add_f32 v123, v123, v139
  v_add_f32 v124, v124, v140
  v_add_f32 v125, v125, v141
  v_add_f32 v126, v126, v142
  v_add_f32 v127, v127, v143
  v_add_f32 v112, v112, v120
  v_add_f32 v113, v113, v121
  v_add_f32 v114, v114, v122
  v_add_f32 v115, v115, v123
  v_add_f32 v116, v116, v124
  v_add_f32 v117, v117, v125
  v_add_f32 v118, v118, v126
  v_add_f32 v119, v119, v127
  v_add_f32 v112, v112, v116
  v_add_f32 v113, v113, v117
  v_add_f32 v114, v114, v118
  v_add_f32 v115, v115, v119
  v_add_f32 v112, v112, v114
  v_add_f32 v113, v113, v115
  v_add_f32 v112, v112, v113
  s_nop 1
  v_add_f32_dpp v112, v112, v112 quad_perm:[1,0,3,2] row_mask:0xf bank_mask:0xf
  s_nop 1
  v_add_f32_dpp v112, v112, v112 quad_perm:[2,3,0,1] row_mask:0xf bank_mask:0xf
  s_nop 1
  v_add_f32_dpp v112, v112, v112 row_ror:8 row_mask:0xf bank_mask:0xf
  v_mov_b32 v10, v112
  s_nop 1
  v_permlane16_swap_b32 v112, v10
  v_add_f32 v112, v112, v10
  v_mov_b32 v10, v112
  s_nop 1
  v_permlane32_swap_b32 v112, v10
  v_add_f32 v112, v112, v10
  v_mov_b32 v30, v112
  s_mov_b64 exec, 0x11
  buffer_store_dwordx4 v[28:31], v14, s[52:55], s60 offen sc1
  s_mov_b64 exec, -1
  s_mov_b32 s61, 3200000
L_w7:
  ds_read_b32 v9, v15 offset:1032
  s_waitcnt lgkmcnt(0)
  v_readfirstlane_b32 s15, v9
  s_nop 3
  s_cmp_ge_u32 s15, 34
  s_cbranch_scc1 L_w7_ok
  s_sleep 2
  s_sub_u32 s61, s61, 1
  s_cmp_lg_u32 s61, 0
  s_cbranch_scc1 L_w7
L_w7_ok:
  s_mov_b32 s60, s2
  s_add_u32 s60, s60, s24
  s_and_b32 s15, s60, 0xff
  s_lshl_b32 s15, s15, 7
  s_add_u32 s15, s15, s26
  s_load_dword s44, s[40:41], s15 glc
  s_add_u32 s60, s60, s24
  s_and_b32 s15, s60, 0xff
  s_lshl_b32 s15, s15, 7
  s_add_u32 s15, s15, s26
  s_load_dword s45, s[40:41], s15 glc
  s_add_u32 s60, s60, s24
  s_and_b32 s15, s60, 0xff
  s_lshl_b32 s15, s15, 7
  s_add_u32 s15, s15, s26
  s_load_dword s46, s[40:41], s15 glc
  s_add_u32 s60, s60, s24
  s_and_b32 s15, s60, 0xff
  s_lshl_b32 s15, s15, 7
  s_add_u32 s15, s15, s26
  s_load_dword s47, s[40:41], s15 glc
  s_add_u32 s60, s60, s24
  s_and_b32 s15, s60, 0xff
  s_lshl_b32 s15, s15, 7
  s_add_u32 s15, s15, s26
  s_load_dword s48, s[40:41], s15 glc
  s_add_u32 s60, s60, s24
  s_and_b32 s15, s60, 0xff
  s_lshl_b32 s15, s15, 7
  s_add_u32 s15, s15, s26
  s_load_dword s49, s[40:41], s15 glc
  s_add_u32 s60, s60, s24
  s_and_b32 s15, s60, 0xff
  s_lshl_b32 s15, s15, 7
  s_add_u32 s15, s15, s26
  s_load_dword s50, s[40:41], s15 glc
  s_add_u32 s60, s60, s24
  s_and_b32 s15, s60, 0xff
  s_lshl_b32 s15, s15, 7
  s_add_u32 s15, s15, s26
  s_load_dword s51, s[40:41], s15 glc
  s_add_u32 s60, s60, s24
  s_and_b32 s15, s60, 0xff
  s_lshl_b32 s15, s15, 7
  s_add_u32 s15, s15, s26
  s_load_dword s16, s[40:41], s15 glc
  s_add_u32 s60, s60, s24
  s_and_b32 s15, s60, 0xff
  s_lshl_b32 s15, s15, 7
  s_add_u32 s15, s15, s26
  s_load_dword s17, s[40:41], s15 glc
  s_add_u32 s60, s60, s24
  s_and_b32 s15, s60, 0xff
  s_lshl_b32 s15, s15, 7
  s_add_u32 s15, s15, s26
  s_load_dword s18, s[40:41], s15 glc
  s_add_u32 s60, s60, s24
  s_and_b32 s15, s60, 0xff
  s_lshl_b32 s15, s15, 7
  s_add_u32 s15, s15, s26
  s_load_dword s19, s[40:41], s15 glc
  s_add_u32 s60, s60, s24
  s_and_b32 s15, s60, 0xff
  s_lshl_b32 s15, s15, 7
  s_add_u32 s15, s15, s26
  s_load_dword s20, s[40:41], s15 glc
  s_add_u32 s60, s60, s24
  s_and_b32 s15, s60, 0xff
  s_lshl_b32 s15, s15, 7
  s_add_u32 s15, s15, s26
  s_load_dword s21, s[40:41], s15 glc
  s_add_u32 s60, s60, s24
  s_and_b32 s15, s60, 0xff
  s_lshl_b32 s15, s15, 7
  s_add_u32 s15, s15, s26
  s_load_dword s22, s[40:41], s15 glc
  s_add_u32 s60, s60, s24
  s_and_b32 s15, s60, 0xff
  s_lshl_b32 s15, s15, 7
  s_add_u32 s15, s15, s26
  s_load_dword s23, s[40:41], s15 glc
  s_add_u32 s24, s24, 24
  s_mov_b64 exec, 1
  buffer_store_dword v89, off, s[52:55], s27 sc1
  s_mov_b64 exec, -1
  s_waitcnt lgkmcnt(0)
  s_mov_b32 s60, 0
  s_cmp_eq_u32 s44, s9
  s_addc_u32 s60, s60, 0
  s_cmp_eq_u32 s45, s9
  s_addc_u32 s60, s60, 0
  s_cmp_eq_u32 s46, s9
  s_addc_u32 s60, s60, 0
  s_cmp_eq_u32 s47, s9
  s_addc_u32 s60, s60, 0
  s_cmp_eq_u32 s48, s9
  s_addc_u32 s60, s60, 0
  s_cmp_eq_u32 s49, s9
  s_addc_u32 s60, s60, 0
  s_cmp_eq_u32 s50, s9
  s_addc_u32 s60, s60, 0
  s_cmp_eq_u32 s51, s9
  s_addc_u32 s60, s60, 0
  s_cmp_eq_u32 s16, s9
  s_addc_u32 s60, s60, 0
  s_cmp_eq_u32 s17, s9
  s_addc_u32 s60, s60, 0
  s_cmp_eq_u32 s18, s9
  s_addc_u32 s60, s60, 0
  s_cmp_eq_u32 s19, s9
  s_addc_u32 s60, s60, 0
  s_cmp_eq_u32 s20, s9
  s_addc_u32 s60, s60, 0
  s_cmp_eq_u32 s21, s9
  s_addc_u32 s60, s60, 0
  s_cmp_eq_u32 s22, s9
  s_addc_u32 s60, s60, 0
  s_cmp_eq_u32 s23, s9
  s_addc_u32 s60, s60, 0
  s_add_u32 s26, s26, 32768
  s_add_u32 s27, s27, 32768
  s_mov_b32 s69, 0
  s_cmp_ge_u32 s60, 3
  s_addc_u32 s69, s69, 0
  s_cmp_ge_u32 s60, 10
  s_addc_u32 s69, s69, 0
  s_cmp_ge_u32 s60, 14
  s_addc_u32 s69, s69, 0
  v_mov_b32 v9, s69
  ds_write_b32 v15, v9 offset:1036
  v_and_b32 v14, 0x1f0, v105
  s_mov_b32 s61, 400000
L_mpoll:
  buffer_load_dwordx4 v[20:23], v14, s[52:55], s71 offen sc1
  s_waitcnt vmcnt(0)
  v_xor_b32 v11, s9, v21
  v_xor_b32 v12, s9, v23
  v_or_b32 v11, v11, v12
  v_cmp_ne_u32 vcc, 0, v11
  s_cbranch_vccz L_mdone
  s_sleep 32
  s_sub_u32 s61, s61, 1
  s_cmp_lg_u32 s61, 0
  s_cbranch_scc1 L_mpoll
L_mdone:
  v_and_b32 v9, 1, v1
  v_lshlrev_b32 v9, 2, v9
  ds_read_b32 v13, v9 offset:1056
  v_mov_b32 v11, v20
  s_nop 1
  v_max_f32_dpp v11, v11, v11 quad_perm:[2,3,0,1] row_mask:0xf bank_mask:0xf
  s_nop 1
  v_max_f32_dpp v11, v11, v11 row_ror:4 row_mask:0xf bank_mask:0xf
  s_nop 1
  v_max_f32_dpp v11, v11, v11 row_ror:8 row_mask:0xf bank_mask:0xf
  v_mov_b32 v10, v11
  s_nop 1
  v_permlane16_swap_b32 v11, v10
  v_max_f32 v11, v11, v10
  v_mul_f32 v11, s10, v11
  v_fma_f32 v20, v20, s10, -v11
  v_exp_f32 v20, v20
  s_waitcnt lgkmcnt(0)
  v_fma_f32 v13, v13, s10, -v11
  v_mul_f32 v22, v22, v20
  v_exp_f32 v13, v13
  s_nop 1
  v_add_f32_dpp v22, v22, v22 quad_perm:[2,3,0,1] row_mask:0xf bank_mask:0xf
  s_nop 1
  v_add_f32_dpp v22, v22, v22 row_ror:4 row_mask:0xf bank_mask:0xf
  s_nop 1
  v_add_f32_dpp v22, v22, v22 row_ror:8 row_mask:0xf bank_mask:0xf
  v_mov_b32 v10, v22
  s_nop 1
  v_permlane16_swap_b32 v22, v10
  v_add_f32 v22, v22, v10
  v_rcp_f32 v22, v22
  s_nop 0
  v_mul_f32 v13, v13, v22
  s_mov_b64 exec, 3
  ds_write_b32 v9, v13 offset:1040
  s_mov_b64 exec, -1
  s_waitcnt lgkmcnt(0)
  v_mov_b32 v9, 1
  ds_write_b32 v15, v9 offset:1048
  s_sub_u32 s69, s2, 64
  s_and_b32 s60, s69, 52
  s_cmp_lg_u32 s60, 52
  s_cselect_b32 s75, 1, 0
  s_cmp_lt_u32 s69, 128
  s_cselect_b32 s75, s75, 0
  s_lshl_b32 s28, s69, 13
  s_add_u32 s28, s28, 1048576
  s_lshr_b32 s29, s69, 6
  s_mul_i32 s29, s29, 896
  s_bfe_u32 s60, s69, 0x20004
  s_lshl_b32 s60, s60, 8
  s_add_u32 s29, s29, s60
  s_and_b32 s60, s69, 7
  s_lshl_b32 s60, s60, 5
  s_add_u32 s29, s29, s60
  s_bfe_u32 s60, s69, 0x10003
  s_lshl_b32 s60, s60, 3
  s_add_u32 s29, s29, s60
  s_mov_b32 s61, 3200000
L_w8:
  ds_read_b32 v9, v15 offset:1032
  s_waitcnt lgkmcnt(0)
  v_readfirstlane_b32 s15, v9
  s_nop 3
  s_cmp_ge_u32 s15, 44
  s_cbranch_scc1 L_w8_ok
  s_sleep 2
  s_sub_u32 s61, s61, 1
  s_cmp_lg_u32 s61, 0
  s_cbranch_scc1 L_w8
L_w8_ok:
  s_mov_b32 s60, s2
  s_add_u32 s60, s60, s24
  s_and_b32 s15, s60, 0xff
  s_lshl_b32 s15, s15, 7
  s_add_u32 s15, s15, s26
  s_load_dword s44, s[40:41], s15 glc
  s_add_u32 s60, s60, s24
  s_and_b32 s15, s60, 0xff
  s_lshl_b32 s15, s15, 7
  s_add_u32 s15, s15, s26
  s_load_dword s45, s[40:41], s15 glc
  s_add_u32 s60, s60, s24
  s_and_b32 s15, s60, 0xff
  s_lshl_b32 s15, s15, 7
  s_add_u32 s15, s15, s26
  s_load_dword s46, s[40:41], s15 glc
  s_add_u32 s60, s60, s24
  s_and_b32 s15, s60, 0xff
  s_lshl_b32 s15, s15, 7
  s_add_u32 s15, s15, s26
  s_load_dword s47, s[40:41], s15 glc
  s_add_u32 s60, s60, s24
  s_and_b32 s15, s60, 0xff
  s_lshl_b32 s15, s15, 7
  s_add_u32 s15, s15, s26
  s_load_dword s48, s[40:41], s15 glc
  s_add_u32 s60, s60, s24
  s_and_b32 s15, s60, 0xff
  s_lshl_b32 s15, s15, 7
  s_add_u32 s15, s15, s26
  s_load_dword s49, s[40:41], s15 glc
  s_add_u32 s60, s60, s24
  s_and_b32 s15, s60, 0xff
  s_lshl_b32 s15, s15, 7
  s_add_u32 s15, s15, s26
  s_load_dword s50, s[40:41], s15 glc
  s_add_u32 s60, s60, s24
  s_and_b32 s15, s60, 0xff
  s_lshl_b32 s15, s15, 7
  s_add_u32 s15, s15, s26
  s_load_dword s51, s[40:41], s15 glc
  s_add_u32 s60, s60, s24
  s_and_b32 s15, s60, 0xff
  s_lshl_b32 s15, s15, 7
  s_add_u32 s15, s15, s26
  s_load_dword s16, s[40:41], s15 glc
  s_add_u32 s60, s60, s24
  s_and_b32 s15, s60, 0xff
  s_lshl_b32 s15, s15, 7
  s_add_u32 s15, s15, s26
  s_load_dword s17, s[40:41], s15 glc
  s_add_u32 s60, s60, s24
  s_and_b32 s15, s60, 0xff
  s_lshl_b32 s15, s15, 7
  s_add_u32 s15, s15, s26
  s_load_dword s18, s[40:41], s15 glc
  s_add_u32 s60, s60, s24
  s_and_b32 s15, s60, 0xff
  s_lshl_b32 s15, s15, 7
  s_add_u32 s15, s15, s26
  s_load_dword s19, s[40:41], s15 glc
  s_add_u32 s60, s60, s24
  s_and_b32 s15, s60, 0xff
  s_lshl_b32 s15, s15, 7
  s_add_u32 s15, s15, s26
  s_load_dword s20, s[40:41], s15 glc
  s_add_u32 s60, s60, s24
  s_and_b32 s15, s60, 0xff
  s_lshl_b32 s15, s15, 7
  s_add_u32 s15, s15, s26
  s_load_dword s21, s[40:41], s15 glc
  s_add_u32 s60, s60, s24
  s_and_b32 s15, s60, 0xff
  s_lshl_b32 s15, s15, 7
  s_add_u32 s15, s15, s26
  s_load_dword s22, s[40:41], s15 glc
  s_add_u32 s60, s60, s24
  s_and_b32 s15, s60, 0xff
  s_lshl_b32 s15, s15, 7
  s_add_u32 s15, s15, s26
  s_load_dword s23, s[40:41], s15 glc
  s_add_u32 s24, s24, 24
  s_mov_b64 exec, 1
  buffer_store_dword v89, off, s[52:55], s27 sc1
  s_mov_b64 exec, -1
  s_waitcnt lgkmcnt(0)
  s_mov_b32 s60, 0
  s_cmp_eq_u32 s44, s9
  s_addc_u32 s60, s60, 0
  s_cmp_eq_u32 s45, s9
  s_addc_u32 s60, s60, 0
  s_cmp_eq_u32 s46, s9
  s_addc_u32 s60, s60, 0
  s_cmp_eq_u32 s47, s9
  s_addc_u32 s60, s60, 0
  s_cmp_eq_u32 s48, s9
  s_addc_u32 s60, s60, 0
  s_cmp_eq_u32 s49, s9
  s_addc_u32 s60, s60, 0
  s_cmp_eq_u32 s50, s9
  s_addc_u32 s60, s60, 0
  s_cmp_eq_u32 s51, s9
  s_addc_u32 s60, s60, 0
  s_cmp_eq_u32 s16, s9
  s_addc_u32 s60, s60, 0
  s_cmp_eq_u32 s17, s9
  s_addc_u32 s60, s60, 0
  s_cmp_eq_u32 s18, s9
  s_addc_u32 s60, s60, 0
  s_cmp_eq_u32 s19, s9
  s_addc_u32 s60, s60, 0
  s_cmp_eq_u32 s20, s9
  s_addc_u32 s60, s60, 0
  s_cmp_eq_u32 s21, s9
  s_addc_u32 s60, s60, 0
  s_cmp_eq_u32 s22, s9
  s_addc_u32 s60, s60, 0
  s_cmp_eq_u32 s23, s9
  s_addc_u32 s60, s60, 0
  s_add_u32 s26, s26, 32768
  s_add_u32 s27, s27, 32768
  s_mov_b32 s69, 0
  s_cmp_ge_u32 s60, 3
  s_addc_u32 s69, s69, 0
  s_cmp_ge_u32 s60, 10
  s_addc_u32 s69, s69, 0
  s_cmp_ge_u32 s60, 14
  s_addc_u32 s69, s69, 0
  v_mov_b32 v9, s69
  ds_write_b32 v15, v9 offset:1036
  s_mov_b32 s61, 3200000
L_w9:
  ds_read_b32 v9, v15 offset:1032
  s_waitcnt lgkmcnt(0)
  v_readfirstlane_b32 s15, v9
  s_nop 3
  s_cmp_ge_u32 s15, 52
  s_cbranch_scc1 L_w9_ok
  s_sleep 2
  s_sub_u32 s61, s61, 1
  s_cmp_lg_u32 s61, 0
  s_cbranch_scc1 L_w9
L_w9_ok:
  s_mov_b32 s60, s2
  s_add_u32 s60, s60, s24
  s_and_b32 s15, s60, 0xff
  s_lshl_b32 s15, s15, 7
  s_add_u32 s15, s15, s26
  s_load_dword s44, s[40:41], s15 glc
  s_add_u32 s60, s60, s24
  s_and_b32 s15, s60, 0xff
  s_lshl_b32 s15, s15, 7
  s_add_u32 s15, s15, s26
  s_load_dword s45, s[40:41], s15 glc
  s_add_u32 s60, s60, s24
  s_and_b32 s15, s60, 0xff
  s_lshl_b32 s15, s15, 7
  s_add_u32 s15, s15, s26
  s_load_dword s46, s[40:41], s15 glc
  s_add_u32 s60, s60, s24
  s_and_b32 s15, s60, 0xff
  s_lshl_b32 s15, s15, 7
  s_add_u32 s15, s15, s26
  s_load_dword s47, s[40:41], s15 glc
  s_add_u32 s60, s60, s24
  s_and_b32 s15, s60, 0xff
  s_lshl_b32 s15, s15, 7
  s_add_u32 s15, s15, s26
  s_load_dword s48, s[40:41], s15 glc
  s_add_u32 s60, s60, s24
  s_and_b32 s15, s60, 0xff
  s_lshl_b32 s15, s15, 7
  s_add_u32 s15, s15, s26
  s_load_dword s49, s[40:41], s15 glc
  s_add_u32 s60, s60, s24
  s_and_b32 s15, s60, 0xff
  s_lshl_b32 s15, s15, 7
  s_add_u32 s15, s15, s26
  s_load_dword s50, s[40:41], s15 glc
  s_add_u32 s60, s60, s24
  s_and_b32 s15, s60, 0xff
  s_lshl_b32 s15, s15, 7
  s_add_u32 s15, s15, s26
  s_load_dword s51, s[40:41], s15 glc
  s_add_u32 s60, s60, s24
  s_and_b32 s15, s60, 0xff
  s_lshl_b32 s15, s15, 7
  s_add_u32 s15, s15, s26
  s_load_dword s16, s[40:41], s15 glc
  s_add_u32 s60, s60, s24
  s_and_b32 s15, s60, 0xff
  s_lshl_b32 s15, s15, 7
  s_add_u32 s15, s15, s26
  s_load_dword s17, s[40:41], s15 glc
  s_add_u32 s60, s60, s24
  s_and_b32 s15, s60, 0xff
  s_lshl_b32 s15, s15, 7
  s_add_u32 s15, s15, s26
  s_load_dword s18, s[40:41], s15 glc
  s_add_u32 s60, s60, s24
  s_and_b32 s15, s60, 0xff
  s_lshl_b32 s15, s15, 7
  s_add_u32 s15, s15, s26
  s_load_dword s19, s[40:41], s15 glc
  s_add_u32 s60, s60, s24
  s_and_b32 s15, s60, 0xff
  s_lshl_b32 s15, s15, 7
  s_add_u32 s15, s15, s26
  s_load_dword s20, s[40:41], s15 glc
  s_add_u32 s60, s60, s24
  s_and_b32 s15, s60, 0xff
  s_lshl_b32 s15, s15, 7
  s_add_u32 s15, s15, s26
  s_load_dword s21, s[40:41], s15 glc
  s_add_u32 s60, s60, s24
  s_and_b32 s15, s60, 0xff
  s_lshl_b32 s15, s15, 7
  s_add_u32 s15, s15, s26
  s_load_dword s22, s[40:41], s15 glc
  s_add_u32 s60, s60, s24
  s_and_b32 s15, s60, 0xff
  s_lshl_b32 s15, s15, 7
  s_add_u32 s15, s15, s26
  s_load_dword s23, s[40:41], s15 glc
  s_add_u32 s24, s24, 24
  s_mov_b64 exec, 1
  buffer_store_dword v89, off, s[52:55], s27 sc1
  s_mov_b64 exec, -1
  s_waitcnt lgkmcnt(0)
  s_mov_b32 s60, 0
  s_cmp_eq_u32 s44, s9
  s_addc_u32 s60, s60, 0
  s_cmp_eq_u32 s45, s9
  s_addc_u32 s60, s60, 0
  s_cmp_eq_u32 s46, s9
  s_addc_u32 s60, s60, 0
  s_cmp_eq_u32 s47, s9
  s_addc_u32 s60, s60, 0
  s_cmp_eq_u32 s48, s9
  s_addc_u32 s60, s60, 0
  s_cmp_eq_u32 s49, s9
  s_addc_u32 s60, s60, 0
  s_cmp_eq_u32 s50, s9
  s_addc_u32 s60, s60, 0
  s_cmp_eq_u32 s51, s9
  s_addc_u32 s60, s60, 0
  s_cmp_eq_u32 s16, s9
  s_addc_u32 s60, s60, 0
  s_cmp_eq_u32 s17, s9
  s_addc_u32 s60, s60, 0
  s_cmp_eq_u32 s18, s9
  s_addc_u32 s60, s60, 0
  s_cmp_eq_u32 s19, s9
  s_addc_u32 s60, s60, 0
  s_cmp_eq_u32 s20, s9
  s_addc_u32 s60, s60, 0
  s_cmp_eq_u32 s21, s9
  s_addc_u32 s60, s60, 0
  s_cmp_eq_u32 s22, s9
  s_addc_u32 s60, s60, 0
  s_cmp_eq_u32 s23, s9
  s_addc_u32 s60, s60, 0
  s_add_u32 s26, s26, 32768
  s_add_u32 s27, s27, 32768
  s_mov_b32 s69, 0
  s_cmp_ge_u32 s60, 3
  s_addc_u32 s69, s69, 0
  s_cmp_ge_u32 s60, 10
  s_addc_u32 s69, s69, 0
  s_cmp_ge_u32 s60, 14
  s_addc_u32 s69, s69, 0
  v_mov_b32 v9, s69
  ds_write_b32 v15, v9 offset:1036
  s_waitcnt vmcnt(0)
  s_mov_b32 s61, 3200000
L_w10:
  ds_read_b32 v9, v15 offset:1028
  s_waitcnt lgkmcnt(0)
  v_readfirstlane_b32 s15, v9
  s_nop 3
  s_cmp_ge_u32 s15, 2
  s_cbranch_scc1 L_w10_ok
  s_sleep 2
  s_sub_u32 s61, s61, 1
  s_cmp_lg_u32 s61, 0
  s_cbranch_scc1 L_w10
L_w10_ok:
  s_setprio 3
  s_cmp_ge_u32 s2, 224
  s_cbranch_scc1 L_now2
  buffer_load_dwordx4 a[0:3], v93, s[76:79], s73 offen offset:0 nt
  buffer_load_dwordx4 a[4:7], v93, s[76:79], s73 offen offset:256 nt
  buffer_load_dwordx4 a[8:11], v93, s[76:79], s73 offen offset:512 nt
  buffer_load_dwordx4 a[16:19], v93, s[76:79], s73 offen offset:896 nt
  buffer_load_dwordx4 a[20:23], v93, s[76:79], s73 offen offset:1152 nt
  buffer_load_dwordx4 a[24:27], v93, s[76:79], s73 offen offset:1408 nt
  s_mov_b32 exec_lo, 0x00ff00ff
  s_mov_b32 exec_hi, 0x00ff00ff
  buffer_load_dwordx4 a[12:15], v93, s[76:79], s73 offen offset:768 nt
  buffer_load_dwordx4 a[28:31], v93, s[76:79], s73 offen offset:1664 nt
  s_mov_b64 exec, -1
  buffer_load_dwordx4 v[176:179], v92, s[56:59], s14 offen offset:0 nt
  buffer_load_dwordx4 v[180:183], v92, s[56:59], s14 offen offset:256 nt
  buffer_load_dwordx4 v[184:187], v92, s[56:59], s14 offen offset:512 nt
  buffer_load_dwordx4 v[192:195], v92, s[56:59], s14 offen offset:896 nt
  buffer_load_dwordx4 v[196:199], v92, s[56:59], s14 offen offset:1152 nt
  buffer_load_dwordx4 v[200:203], v92, s[56:59], s14 offen offset:1408 nt
  buffer_load_dwordx4 v[208:211], v92, s[56:59], s14 offen offset:1792 nt
  buffer_load_dwordx4 v[212:215], v92, s[56:59], s14 offen offset:2048 nt
  buffer_load_dwordx4 v[216:219], v92, s[56:59], s14 offen offset:2304 nt
  buffer_load_dwordx4 v[224:227], v92, s[56:59], s14 offen offset:2688 nt
  buffer_load_dwordx4 v[228:231], v92, s[56:59], s14 offen offset:2944 nt
  buffer_load_dwordx4 v[232:235], v92, s[56:59], s14 offen offset:3200 nt
  s_mov_b32 exec_lo, 0x00ff00ff
  s_mov_b32 exec_hi, 0x00ff00ff
  buffer_load_dwordx4 v[188:191], v92, s[56:59], s14 offen offset:768 nt
  buffer_load_dwordx4 v[204:207], v92, s[56:59], s14 offen offset:1664 nt
  buffer_load_dwordx4 v[220:223], v92, s[56:59], s14 offen offset:2560 nt
  buffer_load_dwordx4 v[236:239], v92, s[56:59], s14 offen offset:3456 nt
  s_mov_b64 exec, -1
  v_sub_f32 v10, 1.0, v104
  v_cvt_pk_bf16_f32 v10, v10, v10
  v_and_b32 v10, 0xffff0000, v10
  s_waitcnt vmcnt(16)
  v_mfma_f32_16x16x32_bf16 v[56:59], v[96:99], a[0:3], 0
  v_mfma_f32_16x16x32_bf16 v[60:63], v[96:99], a[4:7], 0
  v_mfma_f32_16x16x32_bf16 v[64:67], v[96:99], a[8:11], 0
  v_mfma_f32_16x16x32_bf16 v[68:71], v[96:99], a[12:15], 0
  v_mfma_f32_16x16x32_bf16 v[56:59], v[100:103], a[16:19], v[56:59]
  v_mfma_f32_16x16x32_bf16 v[60:63], v[100:103], a[20:23], v[60:63]
  v_mfma_f32_16x16x32_bf16 v[64:67], v[100:103], a[24:27], v[64:67]
  v_mfma_f32_16x16x32_bf16 v[68:71], v[100:103], a[28:31], v[68:71]
  s_nop 4
  v_mul_f32 v56, v56, v10
  v_mul_f32 v57, v57, v10
  v_mul_f32 v58, v58, v10
  v_mul_f32 v59, v59, v10
  v_mul_f32 v60, v60, v10
  v_mul_f32 v61, v61, v10
  v_mul_f32 v62, v62, v10
  v_mul_f32 v63, v63, v10
  v_mul_f32 v64, v64, v10
  v_mul_f32 v65, v65, v10
  v_mul_f32 v66, v66, v10
  v_mul_f32 v67, v67, v10
  v_mul_f32 v68, v68, v10
  v_mul_f32 v69, v69, v10
  v_mul_f32 v70, v70, v10
  v_mul_f32 v71, v71, v10
  s_branch L_w2done
L_now2:
  buffer_load_dwordx4 v[176:179], v92, s[56:59], s14 offen offset:0 nt
  buffer_load_dwordx4 v[180:183], v92, s[56:59], s14 offen offset:256 nt
  buffer_load_dwordx4 v[184:187], v92, s[56:59], s14 offen offset:512 nt
  buffer_load_dwordx4 v[192:195], v92, s[56:59], s14 offen offset:896 nt
  buffer_load_dwordx4 v[196:199], v92, s[56:59], s14 offen offset:1152 nt
  buffer_load_dwordx4 v[200:203], v92, s[56:59], s14 offen offset:1408 nt
  buffer_load_dwordx4 v[208:211], v92, s[56:59], s14 offen offset:1792 nt
  buffer_load_dwordx4 v[212:215], v92, s[56:59], s14 offen offset:2048 nt
  buffer_load_dwordx4 v[216:219], v92, s[56:59], s14 offen offset:2304 nt
  buffer_load_dwordx4 v[224:227], v92, s[56:59], s14 offen offset:2688 nt
  buffer_load_dwordx4 v[228:231], v92, s[56:59], s14 offen offset:2944 nt
  buffer_load_dwordx4 v[232:235], v92, s[56:59], s14 offen offset:3200 nt
  s_mov_b32 exec_lo, 0x00ff00ff
  s_mov_b32 exec_hi, 0x00ff00ff
  buffer_load_dwordx4 v[188:191], v92, s[56:59], s14 offen offset:768 nt
  buffer_load_dwordx4 v[204:207], v92, s[56:59], s14 offen offset:1664 nt
  buffer_load_dwordx4 v[220:223], v92, s[56:59], s14 offen offset:2560 nt
  buffer_load_dwordx4 v[236:239], v92, s[56:59], s14 offen offset:3456 nt
  s_mov_b64 exec, -1
L_w2done:
  s_mov_b32 s56, s36
  s_and_b32 s57, s37, 0xffff
  s_mov_b32 s58, 1792
  s_mov_b32 s59, 0x20000
  s_mov_b32 s11, 0xff
  s_mov_b32 s61, 3200000
L_w11:
  ds_read_b32 v9, v15 offset:1028
  s_waitcnt lgkmcnt(0)
  v_readfirstlane_b32 s15, v9
  s_nop 3
  s_cmp_ge_u32 s15, 3
  s_cbranch_scc1 L_w11_ok
  s_sleep 0
  s_sub_u32 s61, s61, 1
  s_cmp_lg_u32 s61, 0
  s_cbranch_scc1 L_w11
L_w11_ok:
  s_mov_b32 s61, 400000
  s_mov_b64 s[26:27], -1
  s_mov_b64 s[12:13], -1
L_opoll:
  s_mov_b64 exec, s[26:27]
  s_cbranch_execz L_oskip0
  buffer_load_dwordx4 v[112:115], v88, s[52:55], s70 offen offset:0 sc1
L_oskip0:
  s_mov_b64 exec, s[12:13]
  s_cbranch_execz L_oskip1
  buffer_load_dwordx4 v[116:119], v88, s[52:55], s70 offen offset:512 sc1
L_oskip1:
  s_mov_b64 exec, -1
  s_waitcnt vmcnt(0)
  v_perm_b32 v13, v113, v112, s94
  v_perm_b32 v11, v115, v114, s95
  v_bitop3_b32 v13, v13, v11, v106 bitop3:0x96
  v_cmp_ne_u32 s[26:27], 0, v13
  v_perm_b32 v13, v117, v116, s94
  v_perm_b32 v11, v119, v118, s95
  v_bitop3_b32 v13, v13, v11, v106 bitop3:0x96
  v_cmp_ne_u32 s[12:13], 0, v13
  s_or_b64 vcc, s[26:27], s[12:13]
  s_cbranch_scc0 L_odone
  s_sub_u32 s61, s61, 1
  s_cmp_lg_u32 s61, 0
  s_cbranch_scc1 L_opoll
L_odone:
  v_and_b32 v112, s100, v112
  v_and_b32 v113, s100, v113
  v_and_b32 v114, s100, v114
  v_and_b32 v115, s100, v115
  v_and_b32 v116, s100, v116
  v_and_b32 v117, s100, v117
  v_and_b32 v118, s100, v118
  v_and_b32 v119, s100, v119
  v_add_f32 v112, v112, v116
  v_add_f32 v113, v113, v117
  v_add_f32 v114, v114, v118
  v_add_f32 v115, v115, v119
  v_add_f32_dpp v112, v112, v112 quad_perm:[1,0,3,2] row_mask:0xf bank_mask:0xf
  v_add_f32_dpp v113, v113, v113 quad_perm:[1,0,3,2] row_mask:0xf bank_mask:0xf
  v_add_f32_dpp v114, v114, v114 quad_perm:[1,0,3,2] row_mask:0xf bank_mask:0xf
  v_add_f32_dpp v115, v115, v115 quad_perm:[1,0,3,2] row_mask:0xf bank_mask:0xf
  v_add_f32_dpp v112, v112, v112 quad_perm:[2,3,0,1] row_mask:0xf bank_mask:0xf
  v_add_f32_dpp v113, v113, v113 quad_perm:[2,3,0,1] row_mask:0xf bank_mask:0xf
  v_add_f32_dpp v114, v114, v114 quad_perm:[2,3,0,1] row_mask:0xf bank_mask:0xf
  v_add_f32_dpp v115, v115, v115 quad_perm:[2,3,0,1] row_mask:0xf bank_mask:0xf
  v_add_f32_dpp v112, v112, v112 row_half_mirror row_mask:0xf bank_mask:0xf
  v_add_f32_dpp v113, v113, v113 row_half_mirror row_mask:0xf bank_mask:0xf
  v_add_f32_dpp v114, v114, v114 row_half_mirror row_mask:0xf bank_mask:0xf
  v_add_f32_dpp v115, v115, v115 row_half_mirror row_mask:0xf bank_mask:0xf
  v_cvt_pk_bf16_f32 v112, v112, v112
  v_cvt_pk_bf16_f32 v113, v113, v113
  v_cvt_pk_bf16_f32 v114, v114, v114
  v_cvt_pk_bf16_f32 v115, v115, v115
  s_mov_b32 s15, s72
  v_and_b32 v40, v112, v16
  v_and_b32 v41, v112, v17
  v_and_b32 v42, v112, v18
  v_and_b32 v43, v112, v19
  v_and_b32 v44, v113, v16
  v_and_b32 v45, v113, v17
  v_mfma_f32_16x16x32_bf16 v[20:23], v[40:43], v[176:179], 0
  v_and_b32 v46, v113, v18
  v_and_b32 v47, v113, v19
  v_mfma_f32_16x16x32_bf16 v[24:27], v[40:43], v[180:183], 0
  v_and_b32 v48, v114, v16
  v_and_b32 v49, v114, v17
  v_mfma_f32_16x16x32_bf16 v[20:23], v[44:47], v[192:195], v[20:23]
  v_and_b32 v50, v114, v18
  v_and_b32 v51, v114, v19
  v_mfma_f32_16x16x32_bf16 v[24:27], v[44:47], v[196:199], v[24:27]
  v_and_b32 v52, v115, v16
  v_and_b32 v53, v115, v17
  v_mfma_f32_16x16x32_bf16 v[28:31], v[40:43], v[184:187], 0
  v_and_b32 v54, v115, v18
  v_and_b32 v55, v115, v19
  v_mfma_f32_16x16x32_bf16 v[20:23], v[48:51], v[208:211], v[20:23]
  v_mfma_f32_16x16x32_bf16 v[24:27], v[48:51], v[212:215], v[24:27]
  v_mfma_f32_16x16x32_bf16 v[20:23], v[52:55], v[224:227], v[20:23]
  v_mfma_f32_16x16x32_bf16 v[24:27], v[52:55], v[228:231], v[24:27]
  v_mfma_f32_16x16x32_bf16 v[28:31], v[44:47], v[200:203], v[28:31]
  v_mfma_f32_16x16x32_bf16 v[28:31], v[48:51], v[216:219], v[28:31]
  v_mfma_f32_16x16x32_bf16 v[28:31], v[52:55], v[232:235], v[28:31]
  v_mfma_f32_16x16x32_bf16 v[32:35], v[40:43], v[188:191], 0
  v_mfma_f32_16x16x32_bf16 v[32:35], v[44:47], v[204:207], v[32:35]
  v_mfma_f32_16x16x32_bf16 v[32:35], v[48:51], v[220:223], v[32:35]
  v_mfma_f32_16x16x32_bf16 v[32:35], v[52:55], v[236:239], v[32:35]
  v_fmac_f32 v56, v20, v104
  v_fmac_f32 v57, v21, v104
  v_fmac_f32 v58, v22, v104
  v_fmac_f32 v59, v23, v104
  v_perm_b32 v128, v56, v106, s96
  v_perm_b32 v129, v57, v106, s97
  v_perm_b32 v130, v58, v106, s98
  v_perm_b32 v131, v59, v106, s99
  buffer_store_dwordx4 v[128:131], v90, s[52:55], s15 offen sc1
  s_add_u32 s15, s15, 131072
  v_fmac_f32 v60, v24, v104
  v_fmac_f32 v61, v25, v104
  v_fmac_f32 v62, v26, v104
  v_fmac_f32 v63, v27, v104
  v_perm_b32 v132, v60, v106, s96
  v_perm_b32 v133, v61, v106, s97
  v_perm_b32 v134, v62, v106, s98
  v_perm_b32 v135, v63, v106, s99
  buffer_store_dwordx4 v[132:135], v90, s[52:55], s15 offen sc1
  s_add_u32 s15, s15, 131072
  v_fmac_f32 v64, v28, v104
  v_fmac_f32 v65, v29, v104
  v_fmac_f32 v66, v30, v104
  v_fmac_f32 v67, v31, v104
  v_perm_b32 v136, v64, v106, s96
  v_perm_b32 v137, v65, v106, s97
  v_perm_b32 v138, v66, v106, s98
  v_perm_b32 v139, v67, v106, s99
  buffer_store_dwordx4 v[136:139], v90, s[52:55], s15 offen sc1
  s_add_u32 s15, s15, 131072
  v_fmac_f32 v68, v32, v104
  v_fmac_f32 v69, v33, v104
  v_fmac_f32 v70, v34, v104
  v_fmac_f32 v71, v35, v104
  v_perm_b32 v140, v68, v106, s96
  v_perm_b32 v141, v69, v106, s97
  v_perm_b32 v142, v70, v106, s98
  v_perm_b32 v143, v71, v106, s99
  s_mov_b32 exec_lo, 0x00ff00ff
  s_mov_b32 exec_hi, 0x00ff00ff
  buffer_store_dwordx4 v[140:143], v90, s[52:55], s15 offen sc1
  s_mov_b64 exec, -1
  s_cmp_eq_u32 s75, 0
  s_cbranch_scc1 L_end
  s_mov_b32 s61, 400000
  s_waitcnt vmcnt(0)
L_fpoll:
  s_add_u32 s15, s28, 0
  s_bitcmp1_b32 s11, 0
  s_cselect_b32 s15, s15, 8388608
  buffer_load_dwordx4 v[176:179], v105, s[52:55], s15 offen offset:0 sc1
  s_add_u32 s15, s28, 1024
  s_bitcmp1_b32 s11, 1
  s_cselect_b32 s15, s15, 8388608
  buffer_load_dwordx4 v[180:183], v105, s[52:55], s15 offen offset:0 sc1
  s_add_u32 s15, s28, 2048
  s_bitcmp1_b32 s11, 2
  s_cselect_b32 s15, s15, 8388608
  buffer_load_dwordx4 v[184:187], v105, s[52:55], s15 offen offset:0 sc1
  s_add_u32 s15, s28, 3072
  s_bitcmp1_b32 s11, 3
  s_cselect_b32 s15, s15, 8388608
  buffer_load_dwordx4 v[188:191], v105, s[52:55], s15 offen offset:0 sc1
  s_add_u32 s15, s28, 4096
  s_bitcmp1_b32 s11, 4
  s_cselect_b32 s15, s15, 8388608
  buffer_load_dwordx4 v[192:195], v105, s[52:55], s15 offen offset:0 sc1
  s_add_u32 s15, s28, 5120
  s_bitcmp1_b32 s11, 5
  s_cselect_b32 s15, s15, 8388608
  buffer_load_dwordx4 v[196:199], v105, s[52:55], s15 offen offset:0 sc1
  s_add_u32 s15, s28, 6144
  s_bitcmp1_b32 s11, 6
  s_cselect_b32 s15, s15, 8388608
  buffer_load_dwordx4 v[200:203], v105, s[52:55], s15 offen offset:0 sc1
  s_add_u32 s15, s28, 7168
  s_bitcmp1_b32 s11, 7
  s_cselect_b32 s15, s15, 8388608
  buffer_load_dwordx4 v[204:207], v105, s[52:55], s15 offen offset:0 sc1
  s_bitcmp1_b32 s11, 0
  s_cbranch_scc0 L_fchk0
  s_waitcnt vmcnt(7)
  v_perm_b32 v13, v177, v176, s94
  v_perm_b32 v11, v179, v178, s95
  v_bitop3_b32 v13, v13, v11, v106 bitop3:0x96
  v_cmp_ne_u32 vcc, 0, v13
  s_cbranch_vccnz L_fchk0
  v_and_b32 v56, s100, v176
  v_and_b32 v57, s100, v177
  v_and_b32 v58, s100, v178
  v_and_b32 v59, s100, v179
  s_bitset0_b32 s11, 0
L_fchk0:
  s_bitcmp1_b32 s11, 1
  s_cbranch_scc0 L_fchk1
  s_waitcnt vmcnt(6)
  v_perm_b32 v13, v181, v180, s94
  v_perm_b32 v11, v183, v182, s95
  v_bitop3_b32 v13, v13, v11, v106 bitop3:0x96
  v_cmp_ne_u32 vcc, 0, v13
  s_cbranch_vccnz L_fchk1
  v_and_b32 v60, s100, v180
  v_and_b32 v61, s100, v181
  v_and_b32 v62, s100, v182
  v_and_b32 v63, s100, v183
  s_bitset0_b32 s11, 1
L_fchk1:
  s_bitcmp1_b32 s11, 2
  s_cbranch_scc0 L_fchk2
  s_waitcnt vmcnt(5)
  v_perm_b32 v13, v185, v184, s94
  v_perm_b32 v11, v187, v186, s95
  v_bitop3_b32 v13, v13, v11, v106 bitop3:0x96
  v_cmp_ne_u32 vcc, 0, v13
  s_cbranch_vccnz L_fchk2
  v_and_b32 v64, s100, v184
  v_and_b32 v65, s100, v185
  v_and_b32 v66, s100, v186
  v_and_b32 v67, s100, v187
  s_bitset0_b32 s11, 2
L_fchk2:
  s_bitcmp1_b32 s11, 3
  s_cbranch_scc0 L_fchk3
  s_waitcnt vmcnt(4)
  v_perm_b32 v13, v189, v188, s94
  v_perm_b32 v11, v191, v190, s95
  v_bitop3_b32 v13, v13, v11, v106 bitop3:0x96
  v_cmp_ne_u32 vcc, 0, v13
  s_cbranch_vccnz L_fchk3
  v_and_b32 v68, s100, v188
  v_and_b32 v69, s100, v189
  v_and_b32 v70, s100, v190
  v_and_b32 v71, s100, v191
  s_bitset0_b32 s11, 3
L_fchk3:
  s_bitcmp1_b32 s11, 4
  s_cbranch_scc0 L_fchk4
  s_waitcnt vmcnt(3)
  v_perm_b32 v13, v193, v192, s94
  v_perm_b32 v11, v195, v194, s95
  v_bitop3_b32 v13, v13, v11, v106 bitop3:0x96
  v_cmp_ne_u32 vcc, 0, v13
  s_cbranch_vccnz L_fchk4
  v_and_b32 v72, s100, v192
  v_and_b32 v73, s100, v193
  v_and_b32 v74, s100, v194
  v_and_b32 v75, s100, v195
  s_bitset0_b32 s11, 4
L_fchk4:
  s_bitcmp1_b32 s11, 5
  s_cbranch_scc0 L_fchk5
  s_waitcnt vmcnt(2)
  v_perm_b32 v13, v197, v196, s94
  v_perm_b32 v11, v199, v198, s95
  v_bitop3_b32 v13, v13, v11, v106 bitop3:0x96
  v_cmp_ne_u32 vcc, 0, v13
  s_cbranch_vccnz L_fchk5
  v_and_b32 v76, s100, v196
  v_and_b32 v77, s100, v197
  v_and_b32 v78, s100, v198
  v_and_b32 v79, s100, v199
  s_bitset0_b32 s11, 5
L_fchk5:
  s_bitcmp1_b32 s11, 6
  s_cbranch_scc0 L_fchk6
  s_waitcnt vmcnt(1)
  v_perm_b32 v13, v201, v200, s94
  v_perm_b32 v11, v203, v202, s95
  v_bitop3_b32 v13, v13, v11, v106 bitop3:0x96
  v_cmp_ne_u32 vcc, 0, v13
  s_cbranch_vccnz L_fchk6
  v_and_b32 v80, s100, v200
  v_and_b32 v81, s100, v201
  v_and_b32 v82, s100, v202
  v_and_b32 v83, s100, v203
  s_bitset0_b32 s11, 6
L_fchk6:
  s_bitcmp1_b32 s11, 7
  s_cbranch_scc0 L_fchk7
  s_waitcnt vmcnt(0)
  v_perm_b32 v13, v205, v204, s94
  v_perm_b32 v11, v207, v206, s95
  v_bitop3_b32 v13, v13, v11, v106 bitop3:0x96
  v_cmp_ne_u32 vcc, 0, v13
  s_cbranch_vccnz L_fchk7
  v_and_b32 v84, s100, v204
  v_and_b32 v85, s100, v205
  v_and_b32 v86, s100, v206
  v_and_b32 v87, s100, v207
  s_bitset0_b32 s11, 7
L_fchk7:
  s_cmp_eq_u32 s11, 0
  s_cbranch_scc1 L_fdone
  s_sub_u32 s61, s61, 1
  s_cmp_lg_u32 s61, 0
  s_cbranch_scc1 L_fpoll
L_fdone:
  v_pk_add_f32 v[56:57], v[56:57], v[72:73]
  v_pk_add_f32 v[58:59], v[58:59], v[74:75]
  v_pk_add_f32 v[60:61], v[60:61], v[76:77]
  v_pk_add_f32 v[62:63], v[62:63], v[78:79]
  v_pk_add_f32 v[64:65], v[64:65], v[80:81]
  v_pk_add_f32 v[66:67], v[66:67], v[82:83]
  v_pk_add_f32 v[68:69], v[68:69], v[84:85]
  v_pk_add_f32 v[70:71], v[70:71], v[86:87]
  v_pk_add_f32 v[56:57], v[56:57], v[64:65]
  v_pk_add_f32 v[58:59], v[58:59], v[66:67]
  v_pk_add_f32 v[60:61], v[60:61], v[68:69]
  v_pk_add_f32 v[62:63], v[62:63], v[70:71]
  v_add_f32 v20, v56, v60
  v_add_f32 v21, v57, v61
  v_add_f32 v22, v58, v62
  v_add_f32 v23, v59, v63
  v_add_f32_dpp v20, v20, v20 row_ror:8 row_mask:0xf bank_mask:0xf
  v_add_f32_dpp v21, v21, v21 row_ror:8 row_mask:0xf bank_mask:0xf
  v_add_f32_dpp v22, v22, v22 row_ror:8 row_mask:0xf bank_mask:0xf
  v_add_f32_dpp v23, v23, v23 row_ror:8 row_mask:0xf bank_mask:0xf
  v_add_f32_dpp v20, v20, v20 row_ror:4 row_mask:0xf bank_mask:0xf
  v_add_f32_dpp v21, v21, v21 row_ror:4 row_mask:0xf bank_mask:0xf
  v_add_f32_dpp v22, v22, v22 row_ror:4 row_mask:0xf bank_mask:0xf
  v_add_f32_dpp v23, v23, v23 row_ror:4 row_mask:0xf bank_mask:0xf
  v_add_f32_dpp v20, v20, v20 row_ror:2 row_mask:0xf bank_mask:0xf
  v_add_f32_dpp v21, v21, v21 row_ror:2 row_mask:0xf bank_mask:0xf
  v_add_f32_dpp v22, v22, v22 row_ror:2 row_mask:0xf bank_mask:0xf
  v_add_f32_dpp v23, v23, v23 row_ror:2 row_mask:0xf bank_mask:0xf
  v_mov_b32 v24, v20
  v_mov_b32 v25, v21
  v_mov_b32 v26, v22
  v_mov_b32 v27, v23
  v_permlane32_swap_b32 v20, v24
  v_permlane32_swap_b32 v21, v25
  v_permlane32_swap_b32 v22, v26
  v_permlane32_swap_b32 v23, v27
  v_add_f32 v20, v20, v24
  v_add_f32 v21, v21, v25
  v_add_f32 v22, v22, v26
  v_add_f32 v23, v23, v27
  v_mov_b32 v24, v20
  v_mov_b32 v25, v21
  v_mov_b32 v26, v22
  v_mov_b32 v27, v23
  v_permlane16_swap_b32 v20, v24
  v_permlane16_swap_b32 v21, v25
  v_permlane16_swap_b32 v22, v26
  v_permlane16_swap_b32 v23, v27
  v_add_f32 v20, v20, v24
  v_add_f32 v21, v21, v25
  v_add_f32 v22, v22, v26
  v_add_f32 v23, v23, v27
  v_cvt_pk_bf16_f32 v20, v20, v21
  v_cvt_pk_bf16_f32 v21, v22, v23
  s_mov_b64 exec, 3
  buffer_store_dwordx2 v[20:21], v105, s[56:59], s29 offen sc1
  s_mov_b64 exec, -1
  s_cmp_lg_u32 s2, 64
  s_cbranch_scc1 L_end
  s_mov_b64 exec, 1
  buffer_store_dword v89, off, s[52:55], 0 offset:0 sc1
L_end:
L_exit:
  s_endpgm
L_code_end:
.section .rodata,"a"
.p2align 6
.amdhsa_kernel gated_mix__gqa_block_cached__glu_gated_swiglu__decode_kernel
  .amdhsa_next_free_vgpr 512
  .amdhsa_next_free_sgpr 102
  .amdhsa_accum_offset 256
  .amdhsa_group_segment_fixed_size 0
  .amdhsa_kernarg_size 104
  .amdhsa_user_sgpr_count 2
  .amdhsa_user_sgpr_kernarg_segment_ptr 1
  .amdhsa_system_sgpr_workgroup_id_x 1
  .amdhsa_float_denorm_mode_32 3
.end_amdhsa_kernel
```
